```python
import torch

def _softmax(x, axis=-1):
    return torch.softmax(x, dim=axis)
def _gelu(x):
    return torch.nn.functional.gelu(x, approximate="tanh")
def _silu(x):
    return torch.nn.functional.silu(x)
def _sigmoid(x):
    return torch.sigmoid(x)
def _layernorm(x, axis=-1, eps=1e-5):
    m = x.mean(dim=axis, keepdim=True)
    v = x.var(dim=axis, keepdim=True, unbiased=False)
    return (x - m) / torch.sqrt(v + eps)
def _scatter_add(tgt, idx, src, axis=0):
    return tgt.clone().index_add_(axis, idx, src)
def _segment_sum(src, seg, n):
    out = torch.zeros((n,) + src.shape[1:], dtype=src.dtype)
    return out.index_add_(0, seg, src)
def _pad(x, pw):
    flat = tuple(v for pair in reversed(pw) for v in pair)
    return torch.nn.functional.pad(x, flat)

kernel_name = 'recurrent_scan__sliding_block_cached__glu_gated_geglu__decode'

def setup_inputs():

    _w = (lambda a: (lambda t: t.to(torch.bfloat16) if t.is_floating_point() else t)(torch.as_tensor(a)))
    def _A_setup():
        B, Sq, D = 4, 1, 576
        Hq, Hkv, Sk, Dh = 32, 16, 4096, 128
        assert Hq % Hkv == 0, (Hq, Hkv)
        return {
            "x": _w((lambda *s: torch.randn(*s, dtype=torch.bfloat16) * 0.2)(B, Sq, D)),
            "k_cache": _w((lambda *s: torch.randn(*s, dtype=torch.bfloat16) * 1.6)(B, Hkv, Sk, Dh)),
            "v_cache": _w((lambda *s: torch.randn(*s, dtype=torch.bfloat16) * 1.6)(B, Hkv, Sk, Dh)),
            "wq": _w((lambda *s: torch.randn(*s, dtype=torch.bfloat16) * 1.6)(D, Hq * Dh) * (D ** -0.5)),
            "wo": _w((lambda *s: torch.randn(*s, dtype=torch.bfloat16) * 1.6)(Hq * Dh, D) * ((Hq * Dh) ** -0.5)),
        }
    _A_in = _A_setup()

    def _B_setup():
        B, S, Dm, Df = 4, 1, 576, 4608
        return {
            "x": _w((lambda *s: torch.randn(*s, dtype=torch.bfloat16) * 0.2)(B, S, Dm)),
            "w_gate": _w((lambda *s: torch.randn(*s, dtype=torch.bfloat16) * 0.8)(Dm, Df) * (Dm ** -0.5)),
            "w_up": _w((lambda *s: torch.randn(*s, dtype=torch.bfloat16) * 0.8)(Dm, Df) * (Dm ** -0.5)),
            "w_down": _w((lambda *s: torch.randn(*s, dtype=torch.bfloat16) * 0.8)(Df, Dm) * (Df ** -0.5)),
        }
    _B_in = _B_setup()

    return {
        "A_x": _A_in["x"],
        "A_k_cache": _A_in["k_cache"],
        "A_v_cache": _A_in["v_cache"],
        "A_wq": _A_in["wq"],
        "A_wo": _A_in["wo"],
        "B_x": _B_in["x"],
        "B_w_gate": _B_in["w_gate"],
        "B_w_up": _B_in["w_up"],
        "B_w_down": _B_in["w_down"],
    }

def reference(A_x, A_k_cache, A_v_cache, A_wq, A_wo, B_x, B_w_gate, B_w_up, B_w_down):
    def _A_ref(x, k_cache, v_cache, wq, wo):
        B, Sq, D = x.shape
        Hq, Dh = 32, 128
        Hkv, Sk = k_cache.shape[1], k_cache.shape[2]
        W = min(4096, max(256, Sk // 4))
        rep = Hq // Hkv
        q = (lambda x, *d: x.permute(*d))((x @ wq).reshape(B, Sq, Hq, Dh), 0, 2, 1, 3)
        k = (lambda x, n, axis: torch.repeat_interleave(x, n, dim=axis))(k_cache[:, :, Sk - W:, :], rep, axis=1)
        v = (lambda x, n, axis: torch.repeat_interleave(x, n, dim=axis))(v_cache[:, :, Sk - W:, :], rep, axis=1)
        scores = torch.einsum("bhqd,bhkd->bhqk", q, k) * (Dh ** -0.5)
        p = _softmax(scores, axis=-1)
        o = torch.einsum("bhqk,bhkd->bhqd", p, v)
        return (lambda x, *d: x.permute(*d))(o, 0, 2, 1, 3).reshape(B, Sq, Hq * Dh) @ wo

    def _B_ref(x, w_gate, w_up, w_down):
        g = torch.einsum("bsd,df->bsf", x, w_gate)
        u = torch.einsum("bsd,df->bsf", x, w_up)
        h = _gelu(g) * u
        return torch.einsum("bsf,fd->bsd", h, w_down)

    x = A_x
    xn = _layernorm(x, axis=-1)
    s = _A_ref(xn, A_k_cache, A_v_cache, A_wq, A_wo)
    g = _silu(_B_ref(xn, B_w_gate, B_w_up, B_w_down))
    return x + s * g
```

```asm
; @launch grid=(256,1,1) block=(640,1,1) lds=32768
.amdgcn_target "amdgcn-amd-amdhsa--gfx950"
.text
.globl recurrent_scan__sliding_block_cached__glu_gated_geglu__decode_kernel
.p2align 8
.type recurrent_scan__sliding_block_cached__glu_gated_geglu__decode_kernel,@function
recurrent_scan__sliding_block_cached__glu_gated_geglu__decode_kernel:

s_load_dwordx16 s[4:19], s[0:1], 0
s_load_dwordx8 s[20:27], s[0:1], 64
s_lshr_b32 s30, s2, 3
v_readfirstlane_b32 s3, v0
s_cmp_lg_u32 s30, 31
s_cbranch_scc1 L_p00
s_getpc_b64 s[32:33]
L_pc1:
v_lshlrev_b32 v1, 5, v0
v_min_u32 v1, L_last-L_pc1, v1
global_load_dword v39, v1, s[32:33]
L_p00:
s_lshr_b32 s3, s3, 6
v_and_b32 v0, 63, v0
s_cmp_ge_u32 s30, 16
s_cbranch_scc1 L_BC
s_lshr_b32 s33, s30, 3
s_mul_i32 s33, s33, 12
s_and_b32 s31, s2, 7
s_xor_b32 s31, s31, s33
s_cmp_ge_u32 s3, 8
s_cbranch_scc1 L_A89
L_As:
s_and_b32 s32, s30, 6
s_lshl3_add_u32 s32, s32, s31
s_and_b32 s33, s30, 1
s_lshl3_add_u32 s32, s32, s33
s_add_u32 s32, s32, 6
s_lshl_b32 s32, s32, 17
v_lshlrev_b32 v2, 4, v0
s_mul_i32 s49, s3, 33
s_and_b32 s49, s49, 36
s_and_b32 s33, s3, 2
s_lshl_b32 s33, s33, 7
s_or_b32 s49, s49, s33
s_and_b32 s33, s30, 8
s_add_u32 s33, s33, s30
s_lshl_b32 s33, s33, 2
s_xor_b32 s49, s49, s33
s_lshl_b32 s49, s49, 8
v_and_b32 v1, 0x30, v2
v_and_b32 v3, 12, v0
v_lshl_or_b32 v1, v3, 6, v1
v_and_b32 v3, 48, v0
v_lshl_or_b32 v1, v3, 2, v1
s_mov_b32 s43, 0x20000
s_mov_b32 s42, s43
s_waitcnt lgkmcnt(0)
s_add_u32 s40, s6, s32
s_addc_u32 s41, s7, 0
buffer_load_dwordx4 v[40:43], v1, s[40:43], s49 offen nt
s_xor_b32 s48, s49, 0x800
buffer_load_dwordx4 v[44:47], v1, s[40:43], s48 offen nt
s_xor_b32 s48, s49, 0x1000
buffer_load_dwordx4 v[48:51], v1, s[40:43], s48 offen nt
s_xor_b32 s48, s49, 0x1800
buffer_load_dwordx4 v[52:55], v1, s[40:43], s48 offen nt
s_xor_b32 s48, s49, 0x8000
s_add_u32 s36, s8, s32
s_addc_u32 s37, s9, 0
s_mov_b32 s38, 0x20000
s_mov_b32 s39, 0x20000
s_barrier
s_waitcnt vmcnt(3)
buffer_load_dwordx4 v[56:59], v1, s[40:43], s48 offen nt
s_xor_b32 s48, s49, 0x8800
s_waitcnt vmcnt(3)
buffer_load_dwordx4 v[60:63], v1, s[40:43], s48 offen nt
s_xor_b32 s48, s49, 0x9000
s_waitcnt vmcnt(3)
buffer_load_dwordx4 v[64:67], v1, s[40:43], s48 offen nt
s_xor_b32 s48, s49, 0x9800
s_waitcnt vmcnt(3)
buffer_load_dwordx4 v[68:71], v1, s[40:43], s48 offen nt
s_xor_b32 s48, s49, 0x4000
s_waitcnt vmcnt(3)
buffer_load_dwordx4 v[72:75], v1, s[40:43], s48 offen nt
s_xor_b32 s48, s49, 0x4800
s_waitcnt vmcnt(3)
buffer_load_dwordx4 v[76:79], v1, s[40:43], s48 offen nt
s_xor_b32 s48, s49, 0x5000
s_waitcnt vmcnt(3)
buffer_load_dwordx4 v[80:83], v1, s[40:43], s48 offen nt
s_xor_b32 s48, s49, 0x5800
s_waitcnt vmcnt(3)
buffer_load_dwordx4 v[84:87], v1, s[40:43], s48 offen nt
s_xor_b32 s48, s49, 0xc000
s_waitcnt vmcnt(3)
buffer_load_dwordx4 v[88:91], v1, s[40:43], s48 offen nt
s_xor_b32 s48, s49, 0xc800
s_waitcnt vmcnt(3)
buffer_load_dwordx4 v[92:95], v1, s[40:43], s48 offen nt
s_xor_b32 s48, s49, 0xd000
s_waitcnt vmcnt(3)
buffer_load_dwordx4 v[96:99], v1, s[40:43], s48 offen nt
s_xor_b32 s48, s49, 0xd800
s_waitcnt vmcnt(3)
buffer_load_dwordx4 v[100:103], v1, s[40:43], s48 offen nt
s_xor_b32 s48, s49, 0x0
v_mov_b32 v33, 656
v_mov_b32 v34, 1
s_mov_b64 s[44:45], 1
s_mov_b32 s51, 4194304
v_and_b32 v36, 1, v0
v_mul_u32_u24 v36, 0x5555, v36
v_or_b32 v36, 0x8888, v36
s_waitcnt vmcnt(3)
buffer_load_dwordx4 v[104:107], v2, s[36:39], s48 offen nt
s_xor_b32 s48, s49, 0x800
s_mov_b32 s60, 0x3db504f3
s_mov_b32 s62, 0x3fb8aa3b
s_mov_b32 s34, 0x0f0f0f0f
s_mov_b32 s35, s34
s_lshl_b32 s33, s3, 10
v_lshl_add_u32 v32, v0, 4, s33
s_waitcnt vmcnt(3)
buffer_load_dwordx4 v[108:111], v2, s[36:39], s48 offen nt
s_xor_b32 s48, s49, 0x1000
v_and_b32 v4, 0xf0, v1
v_bfe_u32 v7, v0, 3, 1
v_lshl_or_b32 v4, v7, 8, v4
v_mov_b32 v5, 640
v_cndmask_b32 v3, v5, v4, s[34:35]
v_cndmask_b32 v6, v4, v5, s[34:35]
s_lshl3_add_u32 s33, s3, 512
v_lshl_add_u32 v7, v7, 6, s33
s_waitcnt vmcnt(3)
buffer_load_dwordx4 v[112:115], v2, s[36:39], s48 offen nt
s_xor_b32 s48, s49, 0x1800
v_mov_b64 v[24:25], 0
v_mov_b64 v[26:27], 0
v_mov_b64 v[28:29], 0
v_mov_b64 v[30:31], 0
s_waitcnt vmcnt(3)
buffer_load_dwordx4 v[116:119], v2, s[36:39], s48 offen nt
s_xor_b32 s48, s49, 0x8000
s_waitcnt vmcnt(3)
buffer_load_dwordx4 v[120:123], v2, s[36:39], s48 offen nt
s_xor_b32 s48, s49, 0x8800
s_waitcnt vmcnt(3)
buffer_load_dwordx4 v[124:127], v2, s[36:39], s48 offen nt
s_xor_b32 s48, s49, 0x9000
s_cmp_lg_u32 s3, 0
s_cbranch_scc1 L_p0
ds_write_b32 v33, v34
L_p0:
s_waitcnt vmcnt(3)
buffer_load_dwordx4 v[128:131], v2, s[36:39], s48 offen nt
s_xor_b32 s48, s49, 0x9800
s_waitcnt vmcnt(3)
buffer_load_dwordx4 v[132:135], v2, s[36:39], s48 offen nt
s_xor_b32 s48, s49, 0x4000
s_waitcnt vmcnt(3)
buffer_load_dwordx4 v[136:139], v2, s[36:39], s48 offen nt
s_xor_b32 s48, s49, 0x4800
s_waitcnt vmcnt(3)
buffer_load_dwordx4 v[140:143], v2, s[36:39], s48 offen nt
s_xor_b32 s48, s49, 0x5000
s_waitcnt vmcnt(3)
buffer_load_dwordx4 v[144:147], v2, s[36:39], s48 offen nt
s_xor_b32 s48, s49, 0x5800
s_waitcnt vmcnt(3)
buffer_load_dwordx4 v[148:151], v2, s[36:39], s48 offen nt
s_xor_b32 s48, s49, 0xc000
L_qw:
ds_read_b32 v35, v33 offset:4
ds_read_b128 v[8:11], v3
ds_read_b128 v[12:15], v6
s_sub_u32 s51, s51, 1
s_waitcnt lgkmcnt(2)
s_cbranch_scc1 L_qx
v_cmp_eq_u32 vcc, 0, v35
s_cbranch_vccnz L_qw
L_qx:
s_waitcnt lgkmcnt(1)
v_mfma_f32_16x16x32_bf16 v[40:43], v[40:43], v[8:11], 0
v_mfma_f32_16x16x32_bf16 v[44:47], v[44:47], v[8:11], 0
v_mfma_f32_16x16x32_bf16 v[48:51], v[48:51], v[8:11], 0
v_mfma_f32_16x16x32_bf16 v[52:55], v[52:55], v[8:11], 0
v_mfma_f32_16x16x32_bf16 v[56:59], v[56:59], v[8:11], 0
v_mfma_f32_16x16x32_bf16 v[60:63], v[60:63], v[8:11], 0
v_mfma_f32_16x16x32_bf16 v[64:67], v[64:67], v[8:11], 0
v_mfma_f32_16x16x32_bf16 v[68:71], v[68:71], v[8:11], 0
s_waitcnt lgkmcnt(0)
v_mfma_f32_16x16x32_bf16 v[40:43], v[72:75], v[12:15], v[40:43]
v_mfma_f32_16x16x32_bf16 v[44:47], v[76:79], v[12:15], v[44:47]
v_mfma_f32_16x16x32_bf16 v[48:51], v[80:83], v[12:15], v[48:51]
v_mfma_f32_16x16x32_bf16 v[52:55], v[84:87], v[12:15], v[52:55]
v_mfma_f32_16x16x32_bf16 v[56:59], v[88:91], v[12:15], v[56:59]
v_mfma_f32_16x16x32_bf16 v[60:63], v[92:95], v[12:15], v[60:63]
v_mfma_f32_16x16x32_bf16 v[64:67], v[96:99], v[12:15], v[64:67]
v_mfma_f32_16x16x32_bf16 v[68:71], v[100:103], v[12:15], v[68:71]
s_nop 0
v_mov_b32_dpp v16, v40 quad_perm:[0,0,0,0] row_mask:0xf bank_mask:0xf
v_mov_b32_dpp v17, v44 quad_perm:[0,0,0,0] row_mask:0xf bank_mask:0xf
v_mov_b32_dpp v18, v48 quad_perm:[0,0,0,0] row_mask:0xf bank_mask:0xf
v_mov_b32_dpp v19, v52 quad_perm:[0,0,0,0] row_mask:0xf bank_mask:0xf
v_add_f32_dpp v16, v41, v16 quad_perm:[1,1,1,1] row_mask:0xf bank_mask:0xf
v_add_f32_dpp v17, v45, v17 quad_perm:[1,1,1,1] row_mask:0xf bank_mask:0xf
v_add_f32_dpp v18, v49, v18 quad_perm:[1,1,1,1] row_mask:0xf bank_mask:0xf
v_add_f32_dpp v19, v53, v19 quad_perm:[1,1,1,1] row_mask:0xf bank_mask:0xf
v_add_f32_dpp v16, v42, v16 quad_perm:[2,2,2,2] row_mask:0xf bank_mask:0xf
v_add_f32_dpp v17, v46, v17 quad_perm:[2,2,2,2] row_mask:0xf bank_mask:0xf
v_add_f32_dpp v18, v50, v18 quad_perm:[2,2,2,2] row_mask:0xf bank_mask:0xf
v_add_f32_dpp v19, v54, v19 quad_perm:[2,2,2,2] row_mask:0xf bank_mask:0xf
v_add_f32_dpp v16, v43, v16 quad_perm:[3,3,3,3] row_mask:0xf bank_mask:0xf
v_add_f32_dpp v17, v47, v17 quad_perm:[3,3,3,3] row_mask:0xf bank_mask:0xf
v_add_f32_dpp v18, v51, v18 quad_perm:[3,3,3,3] row_mask:0xf bank_mask:0xf
buffer_load_dwordx4 v[152:155], v2, s[36:39], s48 offen nt
s_xor_b32 s48, s49, 0xc800
v_add_f32_dpp v19, v55, v19 quad_perm:[3,3,3,3] row_mask:0xf bank_mask:0xf
v_mov_b32_dpp v20, v56 quad_perm:[0,0,0,0] row_mask:0xf bank_mask:0xf
v_mov_b32_dpp v21, v60 quad_perm:[0,0,0,0] row_mask:0xf bank_mask:0xf
v_mov_b32_dpp v22, v64 quad_perm:[0,0,0,0] row_mask:0xf bank_mask:0xf
v_mov_b32_dpp v23, v68 quad_perm:[0,0,0,0] row_mask:0xf bank_mask:0xf
v_add_f32_dpp v20, v57, v20 quad_perm:[1,1,1,1] row_mask:0xf bank_mask:0xf
v_add_f32_dpp v21, v61, v21 quad_perm:[1,1,1,1] row_mask:0xf bank_mask:0xf
v_add_f32_dpp v22, v65, v22 quad_perm:[1,1,1,1] row_mask:0xf bank_mask:0xf
v_add_f32_dpp v23, v69, v23 quad_perm:[1,1,1,1] row_mask:0xf bank_mask:0xf
v_add_f32_dpp v20, v58, v20 quad_perm:[2,2,2,2] row_mask:0xf bank_mask:0xf
v_add_f32_dpp v21, v62, v21 quad_perm:[2,2,2,2] row_mask:0xf bank_mask:0xf
v_add_f32_dpp v22, v66, v22 quad_perm:[2,2,2,2] row_mask:0xf bank_mask:0xf
v_add_f32_dpp v23, v70, v23 quad_perm:[2,2,2,2] row_mask:0xf bank_mask:0xf
v_add_f32_dpp v20, v59, v20 quad_perm:[3,3,3,3] row_mask:0xf bank_mask:0xf
v_add_f32_dpp v21, v63, v21 quad_perm:[3,3,3,3] row_mask:0xf bank_mask:0xf
v_add_f32_dpp v22, v67, v22 quad_perm:[3,3,3,3] row_mask:0xf bank_mask:0xf
v_add_f32_dpp v23, v71, v23 quad_perm:[3,3,3,3] row_mask:0xf bank_mask:0xf
v_cvt_pk_bf16_f32 v16, 0, v16
v_cvt_pk_bf16_f32 v17, 0, v17
v_cvt_pk_bf16_f32 v18, 0, v18
v_cvt_pk_bf16_f32 v19, 0, v19
v_cvt_pk_bf16_f32 v20, 0, v20
v_cvt_pk_bf16_f32 v21, 0, v21
v_cvt_pk_bf16_f32 v22, 0, v22
v_cvt_pk_bf16_f32 v23, 0, v23
v_mul_f32 v16, s60, v16
v_mul_f32 v17, s60, v17
v_mul_f32 v18, s60, v18
v_mul_f32 v19, s60, v19
v_mul_f32 v20, s60, v20
v_mul_f32 v21, s60, v21
v_mul_f32 v22, s60, v22
v_mul_f32 v23, s60, v23
s_waitcnt vmcnt(4)
buffer_load_dwordx4 v[156:159], v2, s[36:39], s48 offen nt
s_xor_b32 s48, s49, 0xd000
v_cvt_pk_bf16_f32 v16, 0, v16
v_cvt_pk_bf16_f32 v17, 0, v17
v_cvt_pk_bf16_f32 v18, 0, v18
v_cvt_pk_bf16_f32 v19, 0, v19
v_cvt_pk_bf16_f32 v20, 0, v20
v_cvt_pk_bf16_f32 v21, 0, v21
v_cvt_pk_bf16_f32 v22, 0, v22
v_cvt_pk_bf16_f32 v23, 0, v23
v_max3_f32 v4, v16, v17, v18
v_max3_f32 v5, v19, v20, v21
v_max3_f32 v4, v4, v22, v23
v_max_f32 v4, v4, v5
v_mov_b64 v[72:73], 0
v_mov_b64 v[74:75], 0
v_max_f32_dpp v4, v4, v4 row_half_mirror row_mask:0xf bank_mask:0xf
v_mov_b32 v5, v4
v_mov_b64 v[76:77], 0
v_mov_b64 v[78:79], 0
v_permlane16_swap_b32 v4, v5
v_max_f32 v4, v4, v5
v_mov_b32 v5, v4
v_mov_b64 v[80:81], 0
v_mov_b64 v[82:83], 0
v_permlane32_swap_b32 v4, v5
v_max_f32 v4, v4, v5
v_sub_f32 v16, v16, v4
v_sub_f32 v17, v17, v4
v_sub_f32 v18, v18, v4
v_sub_f32 v19, v19, v4
v_sub_f32 v20, v20, v4
v_sub_f32 v21, v21, v4
v_sub_f32 v22, v22, v4
v_sub_f32 v23, v23, v4
s_waitcnt vmcnt(4)
buffer_load_dwordx4 v[160:163], v2, s[36:39], s48 offen nt
s_xor_b32 s48, s49, 0xd800
v_mul_f32 v16, s62, v16
v_mul_f32 v17, s62, v17
v_mul_f32 v18, s62, v18
v_mul_f32 v19, s62, v19
v_mul_f32 v20, s62, v20
v_mul_f32 v21, s62, v21
v_mul_f32 v22, s62, v22
v_mul_f32 v23, s62, v23
v_exp_f32 v16, v16
v_exp_f32 v17, v17
v_exp_f32 v18, v18
v_exp_f32 v19, v19
v_exp_f32 v20, v20
v_exp_f32 v21, v21
v_exp_f32 v22, v22
v_exp_f32 v23, v23
v_cvt_pk_bf16_f32 v8, v16, v17
v_cvt_pk_bf16_f32 v9, v18, v19
v_cvt_pk_bf16_f32 v10, v20, v21
v_cvt_pk_bf16_f32 v11, v22, v23
v_add_f32 v16, v16, v20
v_add_f32 v17, v17, v21
v_add_f32 v18, v18, v22
v_add_f32 v19, v19, v23
v_permlane32_swap_b32 v8, v10
v_permlane32_swap_b32 v9, v11
v_add_f32 v16, v16, v18
v_add_f32 v17, v17, v19
v_add_f32 v16, v16, v17
v_permlane16_swap_b32 v8, v10
v_permlane16_swap_b32 v9, v11
v_add_f32_dpp v5, v16, v16 row_half_mirror row_mask:0xf bank_mask:0xf
v_mov_b32 v6, v5
s_waitcnt vmcnt(4)
buffer_load_dwordx4 v[164:167], v2, s[36:39], s48 offen nt
s_mov_b64 exec, s[34:35]
v_mov_b64 v[24:25], v[8:9]
v_mov_b64 v[26:27], v[10:11]
s_not_b64 exec, exec
v_mov_b64 v[28:29], v[8:9]
v_mov_b64 v[30:31], v[10:11]
s_mov_b64 exec, -1
v_mov_b64 v[84:85], 0
v_mov_b64 v[86:87], 0
v_pk_mov_b32 v[40:41], v[104:105], v[108:109] op_sel:[0,0]
v_pk_mov_b32 v[48:49], v[104:105], v[108:109] op_sel:[1,1]
v_pk_mov_b32 v[56:57], v[106:107], v[110:111] op_sel:[0,0]
v_pk_mov_b32 v[64:65], v[106:107], v[110:111] op_sel:[1,1]
v_pk_mov_b32 v[42:43], v[112:113], v[116:117] op_sel:[0,0]
v_pk_mov_b32 v[50:51], v[112:113], v[116:117] op_sel:[1,1]
v_pk_mov_b32 v[58:59], v[114:115], v[118:119] op_sel:[0,0]
v_pk_mov_b32 v[66:67], v[114:115], v[118:119] op_sel:[1,1]
v_pk_mov_b32 v[44:45], v[120:121], v[124:125] op_sel:[0,0]
v_pk_mov_b32 v[52:53], v[120:121], v[124:125] op_sel:[1,1]
v_pk_mov_b32 v[60:61], v[122:123], v[126:127] op_sel:[0,0]
v_pk_mov_b32 v[68:69], v[122:123], v[126:127] op_sel:[1,1]
v_pk_mov_b32 v[46:47], v[128:129], v[132:133] op_sel:[0,0]
v_pk_mov_b32 v[54:55], v[128:129], v[132:133] op_sel:[1,1]
v_pk_mov_b32 v[62:63], v[130:131], v[134:135] op_sel:[0,0]
v_pk_mov_b32 v[70:71], v[130:131], v[134:135] op_sel:[1,1]
v_permlane16_swap_b32 v5, v6
v_add_f32 v5, v5, v6
v_mov_b32 v6, v5
v_smfmac_f32_16x16x64_bf16 v[72:75], v[24:27], v[40:47], v36
v_smfmac_f32_16x16x64_bf16 v[76:79], v[24:27], v[48:55], v36
v_permlane32_swap_b32 v5, v6
v_add_f32 v5, v5, v6
ds_write_b64 v7, v[4:5]
s_mov_b64 exec, s[44:45]
ds_add_u32 v33, v34 offset:8
s_mov_b64 exec, -1
v_smfmac_f32_16x16x64_bf16 v[80:83], v[24:27], v[56:63], v36
v_smfmac_f32_16x16x64_bf16 v[84:87], v[24:27], v[64:71], v36
s_waitcnt vmcnt(6)
v_pk_mov_b32 v[104:105], v[136:137], v[140:141] op_sel:[0,0]
v_pk_mov_b32 v[112:113], v[136:137], v[140:141] op_sel:[1,1]
v_pk_mov_b32 v[120:121], v[138:139], v[142:143] op_sel:[0,0]
v_pk_mov_b32 v[128:129], v[138:139], v[142:143] op_sel:[1,1]
s_waitcnt vmcnt(4)
v_pk_mov_b32 v[106:107], v[144:145], v[148:149] op_sel:[0,0]
v_pk_mov_b32 v[114:115], v[144:145], v[148:149] op_sel:[1,1]
v_pk_mov_b32 v[122:123], v[146:147], v[150:151] op_sel:[0,0]
v_pk_mov_b32 v[130:131], v[146:147], v[150:151] op_sel:[1,1]
s_waitcnt vmcnt(2)
v_pk_mov_b32 v[108:109], v[152:153], v[156:157] op_sel:[0,0]
v_pk_mov_b32 v[116:117], v[152:153], v[156:157] op_sel:[1,1]
v_pk_mov_b32 v[124:125], v[154:155], v[158:159] op_sel:[0,0]
v_pk_mov_b32 v[132:133], v[154:155], v[158:159] op_sel:[1,1]
s_waitcnt vmcnt(0)
v_pk_mov_b32 v[110:111], v[160:161], v[164:165] op_sel:[0,0]
v_pk_mov_b32 v[126:127], v[162:163], v[166:167] op_sel:[0,0]
v_pk_mov_b32 v[118:119], v[160:161], v[164:165] op_sel:[1,1]
v_pk_mov_b32 v[134:135], v[162:163], v[166:167] op_sel:[1,1]
v_smfmac_f32_16x16x64_bf16 v[72:75], v[28:31], v[104:111], v36
v_smfmac_f32_16x16x64_bf16 v[80:83], v[28:31], v[120:127], v36
v_smfmac_f32_16x16x64_bf16 v[76:79], v[28:31], v[112:119], v36
v_smfmac_f32_16x16x64_bf16 v[84:87], v[28:31], v[128:135], v36
s_nop 5
v_permlane16_swap_b32 v72, v80
v_permlane16_swap_b32 v73, v81
v_pk_add_f32 v[16:17], v[72:73], v[80:81]
v_permlane16_swap_b32 v76, v84
v_permlane16_swap_b32 v77, v85
v_pk_add_f32 v[18:19], v[76:77], v[84:85]
ds_write_b128 v32, v[16:19] offset:4096
s_waitcnt lgkmcnt(0)
s_barrier
s_endpgm
L_A89:
v_mov_b64 v[60:61], 0
v_mov_b32 v31, 640
ds_write2_b64 v31, v[60:61], v[60:61] offset1:1
ds_write2_b64 v31, v[60:61], v[60:61] offset0:2 offset1:3
s_waitcnt lgkmcnt(0)
s_barrier
s_load_dword s28, s[26:27], 0
s_min_u32 s33, s30, 8
s_and_b32 s32, s2, 7
s_mul_i32 s32, s32, 9
s_add_u32 s32, s32, s33
s_lshl1_add_u32 s32, s32, s3
s_sub_u32 s32, s32, 8
v_and_b32 v53, 7, v0
v_lshrrev_b32 v51, 5, v0
v_lshl_add_u32 v51, v53, 1, v51
s_lshl_b32 s33, s32, 5
v_lshl_add_u32 v51, v51, 1, s33
s_bfe_u32 s33, s30, 0x20001
s_cmp_eq_u32 s3, 8
s_cbranch_scc1 L_nt
s_lshl4_add_u32 s34, s33, s31
s_and_b32 s35, s30, 1
s_lshl3_add_u32 s34, s34, s35
s_add_u32 s34, s34, 6
s_lshl_b32 s34, s34, 17
v_mov_b32 v9, s34
global_load_dword v10, v9, s[8:9] nt
L_nt:
s_cmp_ge_u32 s30, 9
s_cbranch_scc1 L_nx
global_load_short_d16_hi v52, v51, s[4:5]
L_nx:
s_mul_i32 s34, s31, 12
s_add_u32 s34, s34, s33
s_lshl_b32 s34, s34, 10
s_add_u32 s34, s34, 8192
v_lshl_add_u32 v64, v0, 4, s34
v_add_u32 v65, 4096, v64
v_add_u32 v66, 8192, v64
s_and_b32 s35, s2, 7
s_lshl_b32 s35, s35, 11
s_bitcmp1_b32 s30, 3
s_cselect_b32 s33, 384, 0
s_add_u32 s35, s35, s33
s_add_u32 s35, s35, 410752
v_min_u32 v30, 23, v0
v_lshl_add_u32 v30, v30, 4, s35
s_getreg_b32 s50, hwreg(HW_REG_XCC_ID, 0, 4)
s_lshl_b32 s50, s50, 8
s_and_b32 s35, s30, 7
s_lshl3_add_u32 s34, s31, s35
v_lshlrev_b32 v7, 3, v0
s_lshl_b32 s35, s34, 7
s_add_u32 s35, s35, 499712
v_lshl_add_u32 v12, v0, 4, s35
v_mov_b32 v13, s50
s_waitcnt lgkmcnt(0)
s_and_b32 s29, s28, 0x7f7f7f7f
s_add_u32 s29, s29, 0x07050301
s_and_b32 s28, s28, 0x80808080
s_xor_b32 s29, s29, s28
s_and_b32 s54, s29, 0xff
s_bfe_u32 s55, s29, 0x80008
s_bfe_u32 s56, s29, 0x80010
s_lshr_b32 s57, s29, 24
v_or_b32 v32, s54, v13
v_or_b32 v33, s55, v13
v_or_b32 v34, s56, v13
v_or_b32 v35, s57, v13
s_cmp_lg_u32 s3, 8
s_cbranch_scc1 L_nz
s_mov_b64 exec, 0xff
global_store_dwordx4 v12, v[32:35], s[26:27]
s_mov_b64 exec, -1
L_nz:
s_lshl1_add_u32 s34, s34, s3
s_sub_u32 s34, s34, 8
s_lshl_b32 s35, s34, 9
s_add_u32 s35, s35, 262144
v_add_u32 v4, s35, v7
s_lshl_b32 s35, s34, 6
s_add_u32 s35, s35, 393216
v_lshl_add_u32 v5, v0, 4, s35
s_lshl_b32 s35, s3, 6
v_mov_b32 v6, s35
s_lshl_b32 s35, s3, 9
v_add_u32 v29, s35, v7
s_mov_b32 s62, 0x3fb8aa3b
v_mov_b32 v28, 0xffffff00
v_and_b32 v3, 1, v0
v_lshlrev_b32 v3, 4, v3
v_bfe_u32 v2, s29, v3, 8
v_add_u32 v3, 8, v3
v_bfe_u32 v3, s29, v3, 8
v_lshrrev_b32 v48, 3, v0
v_mul_u32_u24 v48, 12288, v48
v_lshl_add_u32 v48, v53, 3, v48
s_lshl_b32 s33, s32, 6
s_add_u32 s33, s33, 524288
v_add_u32 v48, s33, v48
v_add_u32 v49, 98304, v48
v_add_u32 v50, 196608, v48
v_mov_b32 v62, s29
s_lshl_b32 s33, s31, 7
s_add_u32 s33, s33, 4096
v_lshl_add_u32 v63, v53, 4, s33
global_load_dword v8, v63, s[26:27] sc1
v_not_b32 v54, v2
v_not_b32 v55, v3
v_not_b32 v56, v2
v_not_b32 v57, v3
v_not_b32 v58, v2
v_not_b32 v59, v3
s_mov_b32 s60, 0xbfb8aa3b
s_mov_b32 s58, 0xff
s_mov_b32 s59, s58
s_mov_b64 s[36:37], -1
s_mov_b64 s[38:39], -1
s_mov_b64 s[40:41], -1
s_waitcnt vmcnt(0)
v_and_b32 v52, 0xffff0000, v52
s_cmp_ge_u32 s30, 9
s_cbranch_scc1 L_nr
s_mov_b64 exec, s[58:59]
global_store_short v51, v60, s[22:23]
s_mov_b64 exec, -1
L_nr:
s_cmp_lg_u32 s3, 8
s_cbranch_scc1 L_cmb
L_Actl:
s_and_b32 s44, s54, 15
s_and_b32 s45, s55, 15
s_and_b32 s46, s56, 15
s_and_b32 s47, s57, 15
s_mov_b32 s51, 4194304
L_spin2:
ds_read_b32 v20, v31 offset:16
s_sub_u32 s51, s51, 1
s_waitcnt lgkmcnt(0)
s_cbranch_scc1 L_spinx3
v_cmp_ne_u32 vcc, 1, v20
s_cbranch_vccnz L_spin2
L_spinx3:
s_setprio 3
s_mov_b32 s51, 1048576
L_poll4:
global_load_dwordx4 v[8:11], v64, s[26:27] sc1
global_load_dwordx4 v[12:15], v65, s[26:27] sc1
global_load_dwordx4 v[16:19], v66, s[26:27] sc1
global_load_dwordx4 v[24:27], v30, s[26:27] sc1
s_sub_u32 s51, s51, 1
s_waitcnt vmcnt(0)
s_cbranch_scc1 L_pollx5
v_xor_b32 v8, s44, v8
v_xor_b32 v9, s45, v9
v_xor_b32 v10, s46, v10
v_xor_b32 v11, s47, v11
v_xor_b32 v12, s44, v12
v_xor_b32 v13, s45, v13
v_xor_b32 v14, s46, v14
v_xor_b32 v15, s47, v15
v_xor_b32 v16, s44, v16
v_xor_b32 v17, s45, v17
v_xor_b32 v18, s46, v18
v_xor_b32 v19, s47, v19
v_or3_b32 v20, v8, v9, v10
v_or3_b32 v20, v20, v11, v12
v_or3_b32 v20, v20, v13, v14
v_or3_b32 v20, v20, v15, v16
v_or3_b32 v20, v20, v17, v18
v_bitop3_b32 v20, v20, v19, 15 bitop3:0xa8
v_cmp_ne_u32 vcc, 0, v20
s_cbranch_vccnz L_poll4
L_pollx5:
v_xor_b32 v24, v32, v24
v_xor_b32 v25, v33, v25
v_xor_b32 v26, v34, v26
v_xor_b32 v27, v35, v27
v_or3_b32 v24, v24, v25, v26
v_or_b32 v24, v24, v27
v_pk_add_f32 v[8:9], v[8:9], v[12:13]
v_pk_add_f32 v[10:11], v[10:11], v[14:15]
v_pk_add_f32 v[8:9], v[8:9], v[16:17]
v_pk_add_f32 v[10:11], v[10:11], v[18:19]
v_cmp_ne_u32 vcc, 0, v24
v_cvt_pk_bf16_f32 v8, v8, v9
v_cvt_pk_bf16_f32 v9, v10, v11
ds_write_b64 v7, v[8:9] offset:0
s_cmp_lg_u64 vcc, 0
s_cselect_b32 s33, 2, 1
v_mov_b32 v10, s33
ds_write_b32 v31, v10 offset:20
s_setprio 0
L_cmb:
s_mov_b32 s51, 4194304
L_spin7:
ds_read_b32 v20, v31 offset:24
s_sub_u32 s51, s51, 1
s_waitcnt lgkmcnt(0)
s_cbranch_scc1 L_spinx8
v_cmp_ne_u32 vcc, 8, v20
s_cbranch_vccnz L_spin7
L_spinx8:
s_setprio 3
ds_read_b32 v30, v31 offset:20
ds_read_b128 v[8:11], v6 offset:0
ds_read_b128 v[12:15], v6 offset:16
ds_read_b128 v[16:19], v6 offset:32
ds_read_b128 v[20:23], v6 offset:48
s_waitcnt lgkmcnt(0)
v_readfirstlane_b32 s33, v30
v_max3_f32 v24, v8, v10, v12
v_max3_f32 v25, v14, v16, v18
v_max3_f32 v24, v24, v20, v22
v_max_f32 v24, v24, v25
v_sub_f32 v8, v8, v24
v_sub_f32 v10, v10, v24
v_sub_f32 v12, v12, v24
v_sub_f32 v14, v14, v24
v_sub_f32 v16, v16, v24
v_sub_f32 v18, v18, v24
v_sub_f32 v20, v20, v24
v_sub_f32 v22, v22, v24
v_mul_f32 v8, s62, v8
v_mul_f32 v10, s62, v10
v_mul_f32 v12, s62, v12
v_mul_f32 v14, s62, v14
v_mul_f32 v16, s62, v16
v_mul_f32 v18, s62, v18
v_mul_f32 v20, s62, v20
v_mul_f32 v22, s62, v22
v_exp_f32 v8, v8
v_exp_f32 v10, v10
v_exp_f32 v12, v12
v_exp_f32 v14, v14
v_exp_f32 v16, v16
v_exp_f32 v18, v18
v_exp_f32 v20, v20
v_exp_f32 v22, v22
v_mul_f32 v25, v8, v9
v_fmac_f32 v25, v10, v11
v_fmac_f32 v25, v12, v13
v_fmac_f32 v25, v14, v15
v_fmac_f32 v25, v16, v17
v_fmac_f32 v25, v18, v19
v_fmac_f32 v25, v20, v21
v_fmac_f32 v25, v22, v23
v_mov_b64 v[26:27], v[24:25]
v_and_or_b32 v24, v24, v28, s54
v_and_or_b32 v25, v25, v28, s55
v_and_or_b32 v26, v26, v28, s56
v_and_or_b32 v27, v27, v28, s57
s_mov_b64 exec, 15
s_cmp_lg_u32 s33, 1
s_cbranch_scc1 L_far9
global_store_dwordx4 v5, v[24:27], s[26:27]
L_pub10:
s_mov_b64 exec, -1
s_barrier
ds_read_b64 v[32:33], v29 offset:0
ds_read_b64 v[34:35], v29 offset:1024
ds_read_b64 v[36:37], v29 offset:2048
ds_read_b64 v[38:39], v29 offset:3072
ds_read_b64 v[40:41], v29 offset:4096
ds_read_b64 v[42:43], v29 offset:5120
ds_read_b64 v[44:45], v29 offset:6144
ds_read_b64 v[46:47], v29 offset:7168
s_waitcnt lgkmcnt(6)
v_pk_mul_f32 v[32:33], v[32:33], v[8:9] op_sel_hi:[1,0]
v_pk_fma_f32 v[32:33], v[34:35], v[10:11], v[32:33] op_sel_hi:[1,0,1]
s_waitcnt lgkmcnt(4)
v_pk_fma_f32 v[32:33], v[36:37], v[12:13], v[32:33] op_sel_hi:[1,0,1]
v_pk_fma_f32 v[32:33], v[38:39], v[14:15], v[32:33] op_sel_hi:[1,0,1]
s_waitcnt lgkmcnt(2)
v_pk_fma_f32 v[32:33], v[40:41], v[16:17], v[32:33] op_sel_hi:[1,0,1]
v_pk_fma_f32 v[32:33], v[42:43], v[18:19], v[32:33] op_sel_hi:[1,0,1]
s_waitcnt lgkmcnt(1)
v_pk_fma_f32 v[32:33], v[44:45], v[20:21], v[32:33] op_sel_hi:[1,0,1]
s_waitcnt lgkmcnt(0)
v_pk_fma_f32 v[32:33], v[46:47], v[22:23], v[32:33] op_sel_hi:[1,0,1]
v_and_or_b32 v32, v32, v28, v2
v_and_or_b32 v33, v33, v28, v3
s_cbranch_scc1 L_far11
global_store_dwordx2 v4, v[32:33], s[26:27]
L_pub12:
s_cmp_ge_u32 s30, 9
s_cbranch_scc1 L_fin
s_barrier
s_cmp_lg_u32 s33, 1
s_cbranch_scc1 L_gx
s_mov_b32 s51, 1048576
L_poll13:
global_load_dwordx4 v[8:11], v63, s[26:27] sc1
s_sub_u32 s51, s51, 1
s_waitcnt vmcnt(0)
s_cbranch_scc1 L_pollx14
v_xor_b32 v8, s54, v8
v_xor_b32 v9, s55, v9
v_xor_b32 v10, s56, v10
v_xor_b32 v11, s57, v11
v_or3_b32 v12, v8, v9, v10
v_or_b32 v12, v12, v11
v_cmp_ne_u32_sdwa vcc, v12, 0 src0_sel:BYTE_0 src1_sel:DWORD
s_cbranch_vccnz L_poll13
L_pollx14:
L_gx:
s_mov_b32 s51, 1048576
L_ap:
s_wqm_b64 exec, s[36:37]
s_cselect_b32 exec_lo, exec_lo, s58
global_atomic_or_x2 v[54:55], v48, v[60:61], s[26:27] sc0 sc1
s_wqm_b64 exec, s[38:39]
s_cselect_b32 exec_lo, exec_lo, s58
global_atomic_or_x2 v[56:57], v49, v[60:61], s[26:27] sc0 sc1
s_wqm_b64 exec, s[40:41]
s_cselect_b32 exec_lo, exec_lo, s58
global_atomic_or_x2 v[58:59], v50, v[60:61], s[26:27] sc0 sc1
s_mov_b64 exec, -1
s_sub_u32 s51, s51, 1
s_cbranch_scc1 L_apx
s_bcnt1_i32_b64 s42, s[36:37]
s_bcnt1_i32_b64 s43, s[38:39]
s_add_u32 s42, s42, s43
s_bcnt1_i32_b64 s43, s[40:41]
s_add_u32 s42, s42, s43
s_cmp_gt_u32 s42, 184
s_cbranch_scc1 L_aw
s_waitcnt vmcnt(6)
L_awx:
v_xor_b32 v16, v54, v2
v_xor_b32 v17, v55, v3
v_xor_b32 v18, v56, v2
v_xor_b32 v19, v57, v3
v_xor_b32 v20, v58, v2
v_xor_b32 v21, v59, v3
v_or_b32 v22, v17, v16
v_or_b32 v23, v19, v18
v_or_b32 v24, v21, v20
v_cmp_ne_u32_sdwa s[36:37], v22, 0 src0_sel:BYTE_0 src1_sel:DWORD
v_cmp_ne_u32_sdwa s[38:39], v23, 0 src0_sel:BYTE_0 src1_sel:DWORD
v_cmp_ne_u32_sdwa s[40:41], v24, 0 src0_sel:BYTE_0 src1_sel:DWORD
s_or_b64 s[42:43], s[36:37], s[38:39]
s_or_b64 s[42:43], s[42:43], s[40:41]
s_cbranch_scc1 L_ap
L_apx:
v_pk_add_f32 v[18:19], v[18:19], v[20:21]
s_nop 0
v_permlane32_swap_b32 v16, v17
v_add_f32 v16, v16, v17
v_permlane32_swap_b32 v18, v19
v_add_f32 v18, v18, v19
s_nop 1
v_permlane16_swap_b32 v16, v18
v_add_f32 v16, v16, v18
s_nop 1
v_add_f32_dpp v16, v16, v16 row_ror:8 row_mask:0xf bank_mask:0xf
v_cvt_pk_bf16_f32 v16, 0, v16
v_mul_f32 v17, s60, v16
v_mov_b32 v18, v16
v_exp_f32 v17, v17
v_mov_b32 v19, v16
v_add_f32 v17, 1.0, v17
v_rcp_f32 v17, v17
v_permlane16_swap_b32 v18, v19
v_mul_f32 v16, v16, v17
v_cvt_pk_bf16_f32 v16, 0, v16
v_mul_f32 v16, v16, v19
v_cvt_pk_bf16_f32 v16, 0, v16
v_add_f32 v16, v16, v52
s_mov_b64 exec, s[58:59]
v_cvt_pk_bf16_f32 v16, 0, v16
global_store_short_d16_hi v51, v16, s[22:23]
s_cmp_lg_u32 s32, 0
s_cbranch_scc1 L_fin
s_mov_b64 exec, 1
global_store_dword v60, v62, s[26:27]
L_fin:
s_endpgm
L_BC:
s_cmp_ge_u32 s30, 31
s_cbranch_scc1 L_H
s_cmp_eq_u32 s3, 9
s_cbranch_scc1 L_LN
s_cmp_lt_u32 s30, 25
s_cbranch_scc1 L_B
s_sub_u32 s33, s30, 25
s_cmp_ge_u32 s33, 3
s_cselect_b32 s34, 1, 0
s_mul_i32 s35, s34, 3
s_sub_u32 s33, s33, s35
s_mul_i32 s34, s34, 12
s_and_b32 s32, s2, 7
s_xor_b32 s32, s32, s34
s_cmp_ge_u32 s3, 4
s_cbranch_scc1 L_Cwo
s_mul_i32 s48, s33, 12288
s_lshl2_add_u32 s34, s32, s3
s_add_u32 s48, s48, s34
s_lshl_b32 s48, s48, 7
s_mov_b32 s61, 8192
v_and_b32 v1, 8, v0
v_lshrrev_b32 v2, 4, v0
v_or_b32 v1, v1, v2
v_mul_u32_u24 v1, 32768, v1
v_and_b32 v2, 7, v0
v_lshl_add_u32 v1, v2, 4, v1
s_mov_b32 s38, 4718592
s_mov_b32 s39, 0x20000
s_waitcnt lgkmcnt(0)
s_mov_b64 s[36:37], s[10:11]
buffer_load_dwordx4 v[40:43], v1, s[36:39], s48 offen nt
s_add_u32 s48, s48, s61
buffer_load_dwordx4 v[44:47], v1, s[36:39], s48 offen nt
s_add_u32 s48, s48, s61
buffer_load_dwordx4 v[48:51], v1, s[36:39], s48 offen nt
s_add_u32 s48, s48, s61
buffer_load_dwordx4 v[52:55], v1, s[36:39], s48 offen nt
s_add_u32 s48, s48, 106496
buffer_load_dwordx4 v[56:59], v1, s[36:39], s48 offen nt
s_add_u32 s48, s48, s61
buffer_load_dwordx4 v[60:63], v1, s[36:39], s48 offen nt
s_add_u32 s48, s48, s61
buffer_load_dwordx4 v[64:67], v1, s[36:39], s48 offen nt
s_add_u32 s48, s48, s61
buffer_load_dwordx4 v[68:71], v1, s[36:39], s48 offen nt
s_add_u32 s48, s48, 368640
s_waitcnt vmcnt(7)
buffer_load_dwordx4 v[72:75], v1, s[36:39], s48 offen nt
s_add_u32 s48, s48, s61
s_waitcnt vmcnt(7)
buffer_load_dwordx4 v[76:79], v1, s[36:39], s48 offen nt
s_add_u32 s48, s48, s61
s_waitcnt vmcnt(7)
buffer_load_dwordx4 v[80:83], v1, s[36:39], s48 offen nt
s_add_u32 s48, s48, s61
s_waitcnt vmcnt(7)
buffer_load_dwordx4 v[84:87], v1, s[36:39], s48 offen nt
s_add_u32 s48, s48, 106496
s_waitcnt vmcnt(7)
buffer_load_dwordx4 v[88:91], v1, s[36:39], s48 offen nt
s_add_u32 s48, s48, s61
s_waitcnt vmcnt(7)
buffer_load_dwordx4 v[92:95], v1, s[36:39], s48 offen nt
s_add_u32 s48, s48, s61
s_waitcnt vmcnt(7)
buffer_load_dwordx4 v[96:99], v1, s[36:39], s48 offen nt
s_add_u32 s48, s48, s61
s_waitcnt vmcnt(7)
buffer_load_dwordx4 v[100:103], v1, s[36:39], s48 offen nt
s_add_u32 s48, s48, 368640
s_load_dword s28, s[26:27], 0
v_bfe_u32 v3, v0, 2, 2
v_mul_u32_u24 v3, 1152, v3
v_bfe_u32 v4, v0, 1, 1
v_lshl_add_u32 v3, v4, 6, v3
v_and_b32 v4, 48, v0
v_add_u32 v3, v3, v4
s_mul_i32 s34, s33, 384
v_add_u32 v3, s34, v3
v_lshrrev_b32 v2, 4, v0
v_mul_u32_u24 v2, 1024, v2
v_and_b32 v4, 7, v0
v_lshl_add_u32 v2, v4, 5, v2
v_and_b32 v4, 8, v0
v_lshl_add_u32 v2, v4, 1, v2
s_mul_i32 s34, s32, 3
s_add_u32 s34, s34, s33
s_lshl_b32 s34, s34, 12
s_lshl_b32 s35, s3, 8
s_add_u32 s34, s34, s35
s_add_u32 s34, s34, 8192
v_add_u32 v2, s34, v2
v_and_b32 v24, 1, v0
v_mul_u32_u24 v24, 0x5555, v24
v_or_b32 v24, 0x8888, v24
v_mov_b64 v[8:9], 0
v_mov_b64 v[10:11], 0
v_mov_b64 v[12:13], 0
v_mov_b64 v[14:15], 0
v_mov_b64 v[16:17], 0
v_mov_b64 v[18:19], 0
v_mov_b64 v[20:21], 0
v_mov_b64 v[22:23], 0
s_waitcnt vmcnt(7)
buffer_load_dwordx4 v[104:107], v1, s[36:39], s48 offen nt
s_add_u32 s48, s48, s61
s_waitcnt vmcnt(7)
buffer_load_dwordx4 v[108:111], v1, s[36:39], s48 offen nt
s_add_u32 s48, s48, s61
s_waitcnt vmcnt(7)
buffer_load_dwordx4 v[112:115], v1, s[36:39], s48 offen nt
s_add_u32 s48, s48, s61
s_waitcnt vmcnt(7)
buffer_load_dwordx4 v[116:119], v1, s[36:39], s48 offen nt
s_add_u32 s48, s48, 106496
s_waitcnt vmcnt(7)
buffer_load_dwordx4 v[120:123], v1, s[36:39], s48 offen nt
s_add_u32 s48, s48, s61
s_waitcnt vmcnt(7)
buffer_load_dwordx4 v[124:127], v1, s[36:39], s48 offen nt
s_add_u32 s48, s48, s61
s_waitcnt vmcnt(7)
buffer_load_dwordx4 v[128:131], v1, s[36:39], s48 offen nt
s_add_u32 s48, s48, s61
s_waitcnt vmcnt(7)
buffer_load_dwordx4 v[132:135], v1, s[36:39], s48 offen nt
s_lshl_b32 s34, s32, 10
s_add_u32 s34, s34, 499712
v_lshl_add_u32 v1, v0, 4, s34
global_load_dwordx4 v[4:7], v1, s[26:27] sc1
s_getreg_b32 s50, hwreg(HW_REG_XCC_ID, 0, 4)
s_lshl_b32 s50, s50, 8
s_waitcnt lgkmcnt(0)
s_and_b32 s29, s28, 0x7f7f7f7f
s_add_u32 s29, s29, 0x07050301
s_and_b32 s28, s28, 0x80808080
s_xor_b32 s29, s29, s28
s_and_b32 s54, s29, 0xff
s_bfe_u32 s55, s29, 0x80008
s_bfe_u32 s56, s29, 0x80010
s_lshr_b32 s57, s29, 24
s_and_b32 s44, s54, 15
s_and_b32 s45, s55, 15
s_and_b32 s46, s56, 15
s_and_b32 s47, s57, 15
s_barrier
ds_read_b128 v[28:31], v3 offset:0
ds_read_b128 v[32:35], v3 offset:128
ds_read_b128 v[36:39], v3 offset:256
v_pk_mov_b32 v[136:137], v[40:41], v[44:45] op_sel:[0,0]
v_pk_mov_b32 v[144:145], v[40:41], v[44:45] op_sel:[1,1]
v_pk_mov_b32 v[152:153], v[42:43], v[46:47] op_sel:[0,0]
v_pk_mov_b32 v[160:161], v[42:43], v[46:47] op_sel:[1,1]
v_pk_mov_b32 v[138:139], v[48:49], v[52:53] op_sel:[0,0]
v_pk_mov_b32 v[146:147], v[48:49], v[52:53] op_sel:[1,1]
v_pk_mov_b32 v[154:155], v[50:51], v[54:55] op_sel:[0,0]
v_pk_mov_b32 v[162:163], v[50:51], v[54:55] op_sel:[1,1]
v_pk_mov_b32 v[140:141], v[56:57], v[60:61] op_sel:[0,0]
v_pk_mov_b32 v[148:149], v[56:57], v[60:61] op_sel:[1,1]
v_pk_mov_b32 v[156:157], v[58:59], v[62:63] op_sel:[0,0]
v_pk_mov_b32 v[164:165], v[58:59], v[62:63] op_sel:[1,1]
v_pk_mov_b32 v[142:143], v[64:65], v[68:69] op_sel:[0,0]
v_pk_mov_b32 v[150:151], v[64:65], v[68:69] op_sel:[1,1]
v_pk_mov_b32 v[158:159], v[66:67], v[70:71] op_sel:[0,0]
v_pk_mov_b32 v[166:167], v[66:67], v[70:71] op_sel:[1,1]
s_waitcnt lgkmcnt(0)
v_smfmac_f32_16x16x64_bf16 v[8:11], v[28:31], v[136:143], v24
v_smfmac_f32_16x16x64_bf16 v[12:15], v[28:31], v[144:151], v24
v_smfmac_f32_16x16x64_bf16 v[16:19], v[28:31], v[152:159], v24
v_smfmac_f32_16x16x64_bf16 v[20:23], v[28:31], v[160:167], v24
v_pk_mov_b32 v[136:137], v[72:73], v[76:77] op_sel:[0,0]
v_pk_mov_b32 v[144:145], v[72:73], v[76:77] op_sel:[1,1]
v_pk_mov_b32 v[152:153], v[74:75], v[78:79] op_sel:[0,0]
v_pk_mov_b32 v[160:161], v[74:75], v[78:79] op_sel:[1,1]
v_pk_mov_b32 v[138:139], v[80:81], v[84:85] op_sel:[0,0]
v_pk_mov_b32 v[146:147], v[80:81], v[84:85] op_sel:[1,1]
v_pk_mov_b32 v[154:155], v[82:83], v[86:87] op_sel:[0,0]
v_pk_mov_b32 v[162:163], v[82:83], v[86:87] op_sel:[1,1]
v_pk_mov_b32 v[140:141], v[88:89], v[92:93] op_sel:[0,0]
v_pk_mov_b32 v[148:149], v[88:89], v[92:93] op_sel:[1,1]
v_pk_mov_b32 v[156:157], v[90:91], v[94:95] op_sel:[0,0]
v_pk_mov_b32 v[164:165], v[90:91], v[94:95] op_sel:[1,1]
v_pk_mov_b32 v[142:143], v[96:97], v[100:101] op_sel:[0,0]
v_pk_mov_b32 v[150:151], v[96:97], v[100:101] op_sel:[1,1]
v_pk_mov_b32 v[158:159], v[98:99], v[102:103] op_sel:[0,0]
v_pk_mov_b32 v[166:167], v[98:99], v[102:103] op_sel:[1,1]
v_smfmac_f32_16x16x64_bf16 v[8:11], v[32:35], v[136:143], v24
v_smfmac_f32_16x16x64_bf16 v[12:15], v[32:35], v[144:151], v24
v_smfmac_f32_16x16x64_bf16 v[16:19], v[32:35], v[152:159], v24
v_smfmac_f32_16x16x64_bf16 v[20:23], v[32:35], v[160:167], v24
s_waitcnt vmcnt(7)
v_pk_mov_b32 v[136:137], v[104:105], v[108:109] op_sel:[0,0]
v_pk_mov_b32 v[144:145], v[104:105], v[108:109] op_sel:[1,1]
v_pk_mov_b32 v[152:153], v[106:107], v[110:111] op_sel:[0,0]
v_pk_mov_b32 v[160:161], v[106:107], v[110:111] op_sel:[1,1]
s_waitcnt vmcnt(5)
v_pk_mov_b32 v[138:139], v[112:113], v[116:117] op_sel:[0,0]
v_pk_mov_b32 v[146:147], v[112:113], v[116:117] op_sel:[1,1]
v_pk_mov_b32 v[154:155], v[114:115], v[118:119] op_sel:[0,0]
v_pk_mov_b32 v[162:163], v[114:115], v[118:119] op_sel:[1,1]
s_waitcnt vmcnt(3)
v_pk_mov_b32 v[140:141], v[120:121], v[124:125] op_sel:[0,0]
v_pk_mov_b32 v[148:149], v[120:121], v[124:125] op_sel:[1,1]
v_pk_mov_b32 v[156:157], v[122:123], v[126:127] op_sel:[0,0]
v_pk_mov_b32 v[164:165], v[122:123], v[126:127] op_sel:[1,1]
s_waitcnt vmcnt(1)
v_pk_mov_b32 v[142:143], v[128:129], v[132:133] op_sel:[0,0]
v_pk_mov_b32 v[150:151], v[128:129], v[132:133] op_sel:[1,1]
v_pk_mov_b32 v[158:159], v[130:131], v[134:135] op_sel:[0,0]
v_pk_mov_b32 v[166:167], v[130:131], v[134:135] op_sel:[1,1]
v_smfmac_f32_16x16x64_bf16 v[8:11], v[36:39], v[136:143], v24
v_smfmac_f32_16x16x64_bf16 v[12:15], v[36:39], v[144:151], v24
v_smfmac_f32_16x16x64_bf16 v[16:19], v[36:39], v[152:159], v24
v_smfmac_f32_16x16x64_bf16 v[20:23], v[36:39], v[160:167], v24
s_waitcnt vmcnt(0)
s_or_b32 s34, s50, s54
v_xor_b32 v4, s34, v4
s_or_b32 s34, s50, s55
v_xor_b32 v5, s34, v5
s_or_b32 s34, s50, s56
v_xor_b32 v6, s34, v6
s_or_b32 s34, s50, s57
v_xor_b32 v7, s34, v7
v_or3_b32 v4, v4, v5, v6
v_or_b32 v4, v4, v7
v_cmp_ne_u32 vcc, 0, v4
v_add_f32_dpp v40, v10, v8 row_ror:8 row_mask:0xf bank_mask:0x3
v_add_f32_dpp v41, v11, v9 row_ror:8 row_mask:0xf bank_mask:0x3
v_add_f32_dpp v42, v14, v12 row_ror:8 row_mask:0xf bank_mask:0x3
v_add_f32_dpp v43, v15, v13 row_ror:8 row_mask:0xf bank_mask:0x3
v_add_f32_dpp v40, v16, v18 row_ror:8 row_mask:0xf bank_mask:0xc
v_add_f32_dpp v41, v17, v19 row_ror:8 row_mask:0xf bank_mask:0xc
v_add_f32_dpp v42, v20, v22 row_ror:8 row_mask:0xf bank_mask:0xc
v_add_f32_dpp v43, v21, v23 row_ror:8 row_mask:0xf bank_mask:0xc
v_and_or_b32 v40, v40, -16, s44
v_and_or_b32 v41, v41, -16, s45
v_and_or_b32 v42, v42, -16, s46
v_and_or_b32 v43, v43, -16, s47
s_cmp_lg_u64 vcc, 0
s_cbranch_scc1 L_far16
global_store_dwordx4 v2, v[40:43], s[26:27]
L_pub17:
s_lshr_b32 s35, s16, 7
s_add_u32 s35, s35, s2
s_and_b32 s35, s35, 7
s_cmp_eq_u32 s35, 3
s_cbranch_scc1 L_c2
L_c2x:
s_setprio 3
s_lshl2_add_u32 s34, s32, s3
s_lshl_b32 s35, s34, 8
s_add_u32 s35, s35, 393216
v_lshrrev_b32 v3, 5, v0
v_lshl_add_u32 v1, v3, 6, s35
v_and_b32 v4, 3, v0
v_lshl_add_u32 v1, v4, 4, v1
s_lshl_b32 s35, s34, 11
s_add_u32 s35, s35, 262144
v_lshl_add_u32 v2, v0, 4, s35
v_and_b32 v4, 15, v0
v_lshlrev_b32 v4, 4, v4
v_lshl_add_u32 v3, v3, 8, v4
v_bfe_u32 v4, v0, 4, 1
v_lshl_add_u32 v3, v4, 3, v3
s_lshl_b32 s35, s3, 9
v_add_u32 v3, s35, v3
s_mov_b32 s62, 0x3fb8aa3b
s_lshl_b32 s35, s32, 7
s_add_u32 s35, s35, 4096
v_lshl_add_u32 v24, v0, 4, s35
v_mov_b32 v28, s54
v_mov_b32 v29, s55
v_mov_b32 v30, s56
v_mov_b32 v31, s57
s_barrier
s_barrier
global_load_dwordx4 v[16:19], v2, s[26:27] sc1
global_load_dwordx4 v[20:23], v2, s[26:27] offset:1024 sc1
s_mov_b32 s51, 1048576
L_poll18:
global_load_dwordx4 v[8:11], v1, s[26:27] sc1
global_load_dwordx4 v[12:15], v1, s[26:27] offset:128 sc1
s_sub_u32 s51, s51, 1
s_waitcnt vmcnt(0)
s_cbranch_scc1 L_pollx19
v_xor_b32 v8, s54, v8
v_xor_b32 v9, s55, v9
v_xor_b32 v10, s56, v10
v_xor_b32 v11, s57, v11
v_xor_b32 v12, s54, v12
v_xor_b32 v13, s55, v13
v_xor_b32 v14, s56, v14
v_xor_b32 v15, s57, v15
v_or3_b32 v4, v8, v9, v10
v_or3_b32 v4, v4, v11, v12
v_or3_b32 v4, v4, v13, v14
v_or_b32 v4, v4, v15
v_cmp_ne_u32_sdwa vcc, v4, 0 src0_sel:BYTE_0 src1_sel:DWORD
s_cbranch_vccnz L_poll18
L_pollx19:
s_or_b32 s34, s33, s3
s_cbranch_scc1 L_go21
s_mov_b64 exec, 0xff
global_store_dwordx4 v24, v[28:31], s[26:27]
s_mov_b64 exec, -1
L_go21:
global_load_dwordx4 v[32:35], v2, s[26:27] sc1
global_load_dwordx4 v[36:39], v2, s[26:27] offset:1024 sc1
v_max_f32 v10, v8, v12
v_sub_f32 v8, v8, v10
v_sub_f32 v12, v12, v10
v_mul_f32 v8, s62, v8
v_mul_f32 v12, s62, v12
v_exp_f32 v8, v8
v_exp_f32 v12, v12
v_mul_f32 v9, v8, v9
v_fmac_f32 v9, v12, v13
v_rcp_f32 v9, v9
s_nop 0
v_mul_f32 v8, v8, v9
v_mul_f32 v12, v12, v9
s_mov_b32 s51, 1048576
L_op:
global_load_dwordx4 v[32:35], v2, s[26:27] sc1
global_load_dwordx4 v[36:39], v2, s[26:27] offset:1024 sc1
s_sub_u32 s51, s51, 1
s_waitcnt vmcnt(2)
s_cbranch_scc1 L_opx
v_xor_b32 v16, s54, v32
v_xor_b32 v17, s55, v33
v_xor_b32 v18, s56, v34
v_xor_b32 v19, s57, v35
v_xor_b32 v20, s54, v36
v_xor_b32 v21, s55, v37
v_xor_b32 v22, s56, v38
v_xor_b32 v23, s57, v39
v_or3_b32 v4, v16, v17, v18
v_or3_b32 v4, v4, v19, v20
v_or3_b32 v4, v4, v21, v22
v_or_b32 v4, v4, v23
v_cmp_ne_u32_sdwa vcc, v4, 0 src0_sel:BYTE_0 src1_sel:DWORD
s_cbranch_vccnz L_op
L_opx:
v_pk_mul_f32 v[16:17], v[16:17], v[8:9] op_sel_hi:[1,0]
v_pk_mul_f32 v[18:19], v[18:19], v[8:9] op_sel_hi:[1,0]
v_pk_fma_f32 v[16:17], v[20:21], v[12:13], v[16:17] op_sel_hi:[1,0,1]
v_pk_fma_f32 v[18:19], v[22:23], v[12:13], v[18:19] op_sel_hi:[1,0,1]
v_cvt_pk_bf16_f32 v16, v16, v17
v_cvt_pk_bf16_f32 v17, v18, v19
ds_write_b64 v3, v[16:17] offset:4608
s_waitcnt lgkmcnt(0)
s_barrier
s_endpgm
.p2align 3
s_nop 0
L_Cwo:
s_cmp_ge_u32 s3, 7
s_waitcnt lgkmcnt(0)
s_cbranch_scc1 L_fin
s_load_dword s28, s[26:27], 0
s_mul_i32 s33, s33, 3
s_add_u32 s33, s33, s3
s_sub_u32 s33, s33, 4
s_mul_i32 s48, s32, 294912
s_lshl_b32 s49, s33, 7
s_add_u32 s48, s48, s49
s_mov_b64 s[36:37], s[12:13]
s_mov_b32 s38, 4718592
s_mov_b32 s39, 0x20000
v_and_b32 v2, 8, v0
v_lshrrev_b32 v3, 4, v0
v_or_b32 v2, v2, v3
v_mul_u32_u24 v2, 4608, v2
v_and_b32 v3, 7, v0
v_lshl_add_u32 v2, v3, 4, v2
v_bfe_u32 v3, v0, 2, 2
v_mul_u32_u24 v3, 512, v3
v_bfe_u32 v4, v0, 1, 1
v_lshl_add_u32 v3, v4, 6, v3
v_and_b32 v4, 48, v0
v_add_u32 v3, v3, v4
v_lshrrev_b32 v1, 4, v0
v_mul_u32_u24 v1, 2304, v1
v_and_b32 v4, 7, v0
v_lshl_add_u32 v1, v4, 5, v1
v_and_b32 v4, 8, v0
v_lshl_add_u32 v1, v4, 1, v1
s_mul_i32 s34, s32, 12288
s_lshl_b32 s35, s33, 8
s_add_u32 s34, s34, s35
s_add_u32 s34, s34, 622592
v_add_u32 v1, s34, v1
v_and_b32 v4, 1, v0
v_mul_u32_u24 v4, 0x5555, v4
v_or_b32 v4, 0x8888, v4
v_mov_b32 v5, 0xffffff00
s_waitcnt lgkmcnt(0)
s_and_b32 s29, s28, 0x7f7f7f7f
s_add_u32 s29, s29, 0x07050301
s_and_b32 s28, s28, 0x80808080
s_xor_b32 s29, s29, s28
s_and_b32 s54, s29, 0xff
s_bfe_u32 s55, s29, 0x80008
s_bfe_u32 s56, s29, 0x80010
s_lshr_b32 s57, s29, 24
s_barrier
s_barrier
buffer_load_dwordx4 v[40:43], v2, s[36:39], s48 offen offset:0 nt
buffer_load_dwordx4 v[44:47], v2, s[36:39], s48 offen offset:1152 nt
buffer_load_dwordx4 v[48:51], v2, s[36:39], s48 offen offset:2304 nt
buffer_load_dwordx4 v[52:55], v2, s[36:39], s48 offen offset:3456 nt
s_add_u32 s48, s48, 18432
buffer_load_dwordx4 v[56:59], v2, s[36:39], s48 offen offset:0 nt
buffer_load_dwordx4 v[60:63], v2, s[36:39], s48 offen offset:1152 nt
buffer_load_dwordx4 v[64:67], v2, s[36:39], s48 offen offset:2304 nt
buffer_load_dwordx4 v[68:71], v2, s[36:39], s48 offen offset:3456 nt
s_add_u32 s48, s48, 55296
buffer_load_dwordx4 v[72:75], v2, s[36:39], s48 offen offset:0 nt
buffer_load_dwordx4 v[76:79], v2, s[36:39], s48 offen offset:1152 nt
s_waitcnt vmcnt(9)
buffer_load_dwordx4 v[80:83], v2, s[36:39], s48 offen offset:2304 nt
s_waitcnt vmcnt(9)
buffer_load_dwordx4 v[84:87], v2, s[36:39], s48 offen offset:3456 nt
s_add_u32 s48, s48, 18432
v_pk_mov_b32 v[8:9], v[40:41], v[44:45] op_sel:[0,0]
v_pk_mov_b32 v[16:17], v[40:41], v[44:45] op_sel:[1,1]
v_pk_mov_b32 v[24:25], v[42:43], v[46:47] op_sel:[0,0]
v_pk_mov_b32 v[32:33], v[42:43], v[46:47] op_sel:[1,1]
s_waitcnt vmcnt(9)
buffer_load_dwordx4 v[88:91], v2, s[36:39], s48 offen offset:0 nt
s_waitcnt vmcnt(9)
buffer_load_dwordx4 v[92:95], v2, s[36:39], s48 offen offset:1152 nt
v_pk_mov_b32 v[10:11], v[48:49], v[52:53] op_sel:[0,0]
v_pk_mov_b32 v[18:19], v[48:49], v[52:53] op_sel:[1,1]
v_pk_mov_b32 v[26:27], v[50:51], v[54:55] op_sel:[0,0]
v_pk_mov_b32 v[34:35], v[50:51], v[54:55] op_sel:[1,1]
s_waitcnt vmcnt(9)
buffer_load_dwordx4 v[96:99], v2, s[36:39], s48 offen offset:2304 nt
s_waitcnt vmcnt(9)
buffer_load_dwordx4 v[100:103], v2, s[36:39], s48 offen offset:3456 nt
s_add_u32 s48, s48, 55296
v_pk_mov_b32 v[12:13], v[56:57], v[60:61] op_sel:[0,0]
v_pk_mov_b32 v[20:21], v[56:57], v[60:61] op_sel:[1,1]
v_pk_mov_b32 v[28:29], v[58:59], v[62:63] op_sel:[0,0]
v_pk_mov_b32 v[36:37], v[58:59], v[62:63] op_sel:[1,1]
s_waitcnt vmcnt(9)
buffer_load_dwordx4 v[104:107], v2, s[36:39], s48 offen offset:0 nt
s_waitcnt vmcnt(9)
buffer_load_dwordx4 v[108:111], v2, s[36:39], s48 offen offset:1152 nt
v_pk_mov_b32 v[14:15], v[64:65], v[68:69] op_sel:[0,0]
v_pk_mov_b32 v[22:23], v[64:65], v[68:69] op_sel:[1,1]
v_pk_mov_b32 v[30:31], v[66:67], v[70:71] op_sel:[0,0]
v_pk_mov_b32 v[38:39], v[66:67], v[70:71] op_sel:[1,1]
s_waitcnt vmcnt(9)
buffer_load_dwordx4 v[112:115], v2, s[36:39], s48 offen offset:2304 nt
s_waitcnt vmcnt(9)
buffer_load_dwordx4 v[116:119], v2, s[36:39], s48 offen offset:3456 nt
s_add_u32 s48, s48, 18432
v_pk_mov_b32 v[40:41], v[72:73], v[76:77] op_sel:[0,0]
v_pk_mov_b32 v[48:49], v[72:73], v[76:77] op_sel:[1,1]
v_pk_mov_b32 v[56:57], v[74:75], v[78:79] op_sel:[0,0]
v_pk_mov_b32 v[64:65], v[74:75], v[78:79] op_sel:[1,1]
s_waitcnt vmcnt(9)
buffer_load_dwordx4 v[120:123], v2, s[36:39], s48 offen offset:0 nt
s_waitcnt vmcnt(9)
buffer_load_dwordx4 v[124:127], v2, s[36:39], s48 offen offset:1152 nt
v_pk_mov_b32 v[42:43], v[80:81], v[84:85] op_sel:[0,0]
v_pk_mov_b32 v[50:51], v[80:81], v[84:85] op_sel:[1,1]
v_pk_mov_b32 v[58:59], v[82:83], v[86:87] op_sel:[0,0]
v_pk_mov_b32 v[66:67], v[82:83], v[86:87] op_sel:[1,1]
s_waitcnt vmcnt(9)
buffer_load_dwordx4 v[128:131], v2, s[36:39], s48 offen offset:2304 nt
s_waitcnt vmcnt(9)
buffer_load_dwordx4 v[132:135], v2, s[36:39], s48 offen offset:3456 nt
s_add_u32 s48, s48, 55296
v_pk_mov_b32 v[44:45], v[88:89], v[92:93] op_sel:[0,0]
v_pk_mov_b32 v[52:53], v[88:89], v[92:93] op_sel:[1,1]
v_pk_mov_b32 v[60:61], v[90:91], v[94:95] op_sel:[0,0]
v_pk_mov_b32 v[68:69], v[90:91], v[94:95] op_sel:[1,1]
s_waitcnt vmcnt(9)
buffer_load_dwordx4 v[136:139], v2, s[36:39], s48 offen offset:0 nt
s_waitcnt vmcnt(9)
buffer_load_dwordx4 v[140:143], v2, s[36:39], s48 offen offset:1152 nt
v_pk_mov_b32 v[46:47], v[96:97], v[100:101] op_sel:[0,0]
v_pk_mov_b32 v[54:55], v[96:97], v[100:101] op_sel:[1,1]
v_pk_mov_b32 v[62:63], v[98:99], v[102:103] op_sel:[0,0]
v_pk_mov_b32 v[70:71], v[98:99], v[102:103] op_sel:[1,1]
s_waitcnt vmcnt(9)
buffer_load_dwordx4 v[144:147], v2, s[36:39], s48 offen offset:2304 nt
s_waitcnt vmcnt(9)
buffer_load_dwordx4 v[148:151], v2, s[36:39], s48 offen offset:3456 nt
s_add_u32 s48, s48, 18432
v_pk_mov_b32 v[72:73], v[104:105], v[108:109] op_sel:[0,0]
v_pk_mov_b32 v[80:81], v[104:105], v[108:109] op_sel:[1,1]
v_pk_mov_b32 v[88:89], v[106:107], v[110:111] op_sel:[0,0]
v_pk_mov_b32 v[96:97], v[106:107], v[110:111] op_sel:[1,1]
s_waitcnt vmcnt(9)
buffer_load_dwordx4 v[152:155], v2, s[36:39], s48 offen offset:0 nt
s_waitcnt vmcnt(9)
buffer_load_dwordx4 v[156:159], v2, s[36:39], s48 offen offset:1152 nt
v_pk_mov_b32 v[74:75], v[112:113], v[116:117] op_sel:[0,0]
v_pk_mov_b32 v[82:83], v[112:113], v[116:117] op_sel:[1,1]
v_pk_mov_b32 v[90:91], v[114:115], v[118:119] op_sel:[0,0]
v_pk_mov_b32 v[98:99], v[114:115], v[118:119] op_sel:[1,1]
s_waitcnt vmcnt(9)
buffer_load_dwordx4 v[160:163], v2, s[36:39], s48 offen offset:2304 nt
s_waitcnt vmcnt(9)
buffer_load_dwordx4 v[164:167], v2, s[36:39], s48 offen offset:3456 nt
v_pk_mov_b32 v[76:77], v[120:121], v[124:125] op_sel:[0,0]
v_pk_mov_b32 v[84:85], v[120:121], v[124:125] op_sel:[1,1]
v_pk_mov_b32 v[92:93], v[122:123], v[126:127] op_sel:[0,0]
v_pk_mov_b32 v[100:101], v[122:123], v[126:127] op_sel:[1,1]
s_barrier
s_waitcnt vmcnt(8)
v_pk_mov_b32 v[78:79], v[128:129], v[132:133] op_sel:[0,0]
v_pk_mov_b32 v[86:87], v[128:129], v[132:133] op_sel:[1,1]
v_pk_mov_b32 v[94:95], v[130:131], v[134:135] op_sel:[0,0]
v_pk_mov_b32 v[102:103], v[130:131], v[134:135] op_sel:[1,1]
s_waitcnt vmcnt(6)
v_pk_mov_b32 v[104:105], v[136:137], v[140:141] op_sel:[0,0]
v_pk_mov_b32 v[112:113], v[136:137], v[140:141] op_sel:[1,1]
v_pk_mov_b32 v[120:121], v[138:139], v[142:143] op_sel:[0,0]
v_pk_mov_b32 v[128:129], v[138:139], v[142:143] op_sel:[1,1]
s_waitcnt vmcnt(4)
v_pk_mov_b32 v[106:107], v[144:145], v[148:149] op_sel:[0,0]
v_pk_mov_b32 v[114:115], v[144:145], v[148:149] op_sel:[1,1]
v_pk_mov_b32 v[122:123], v[146:147], v[150:151] op_sel:[0,0]
v_pk_mov_b32 v[130:131], v[146:147], v[150:151] op_sel:[1,1]
v_mov_b64 v[136:137], 0
v_mov_b64 v[138:139], 0
v_mov_b64 v[140:141], 0
v_mov_b64 v[142:143], 0
v_mov_b64 v[144:145], 0
v_mov_b64 v[146:147], 0
v_mov_b64 v[148:149], 0
v_mov_b64 v[150:151], 0
s_waitcnt vmcnt(2)
v_pk_mov_b32 v[108:109], v[152:153], v[156:157] op_sel:[0,0]
v_pk_mov_b32 v[116:117], v[152:153], v[156:157] op_sel:[1,1]
v_pk_mov_b32 v[124:125], v[154:155], v[158:159] op_sel:[0,0]
v_pk_mov_b32 v[132:133], v[154:155], v[158:159] op_sel:[1,1]
s_waitcnt vmcnt(0)
v_pk_mov_b32 v[110:111], v[160:161], v[164:165] op_sel:[0,0]
v_pk_mov_b32 v[118:119], v[160:161], v[164:165] op_sel:[1,1]
v_pk_mov_b32 v[126:127], v[162:163], v[166:167] op_sel:[0,0]
v_pk_mov_b32 v[134:135], v[162:163], v[166:167] op_sel:[1,1]
s_barrier
ds_read_b128 v[152:155], v3 offset:4608
ds_read_b128 v[156:159], v3 offset:4736
ds_read_b128 v[160:163], v3 offset:4864
ds_read_b128 v[164:167], v3 offset:4992
s_waitcnt lgkmcnt(3)
v_smfmac_f32_16x16x64_bf16 v[136:139], v[152:155], v[8:15], v4
v_smfmac_f32_16x16x64_bf16 v[140:143], v[152:155], v[16:23], v4
v_smfmac_f32_16x16x64_bf16 v[144:147], v[152:155], v[24:31], v4
v_smfmac_f32_16x16x64_bf16 v[148:151], v[152:155], v[32:39], v4
s_waitcnt lgkmcnt(2)
v_smfmac_f32_16x16x64_bf16 v[136:139], v[156:159], v[40:47], v4
v_smfmac_f32_16x16x64_bf16 v[140:143], v[156:159], v[48:55], v4
v_smfmac_f32_16x16x64_bf16 v[144:147], v[156:159], v[56:63], v4
v_smfmac_f32_16x16x64_bf16 v[148:151], v[156:159], v[64:71], v4
s_waitcnt lgkmcnt(1)
v_smfmac_f32_16x16x64_bf16 v[136:139], v[160:163], v[72:79], v4
v_smfmac_f32_16x16x64_bf16 v[140:143], v[160:163], v[80:87], v4
v_smfmac_f32_16x16x64_bf16 v[144:147], v[160:163], v[88:95], v4
v_smfmac_f32_16x16x64_bf16 v[148:151], v[160:163], v[96:103], v4
s_waitcnt lgkmcnt(0)
v_smfmac_f32_16x16x64_bf16 v[136:139], v[164:167], v[104:111], v4
v_smfmac_f32_16x16x64_bf16 v[140:143], v[164:167], v[112:119], v4
v_smfmac_f32_16x16x64_bf16 v[144:147], v[164:167], v[120:127], v4
v_smfmac_f32_16x16x64_bf16 v[148:151], v[164:167], v[128:135], v4
s_nop 4
v_add_f32_dpp v8, v138, v136 row_ror:8 row_mask:0xf bank_mask:0x3
v_add_f32_dpp v9, v139, v137 row_ror:8 row_mask:0xf bank_mask:0x3
v_add_f32_dpp v10, v142, v140 row_ror:8 row_mask:0xf bank_mask:0x3
v_add_f32_dpp v11, v143, v141 row_ror:8 row_mask:0xf bank_mask:0x3
v_add_f32_dpp v8, v144, v146 row_ror:8 row_mask:0xf bank_mask:0xc
v_add_f32_dpp v9, v145, v147 row_ror:8 row_mask:0xf bank_mask:0xc
v_add_f32_dpp v10, v148, v150 row_ror:8 row_mask:0xf bank_mask:0xc
v_add_f32_dpp v11, v149, v151 row_ror:8 row_mask:0xf bank_mask:0xc
v_and_or_b32 v8, v8, v5, s54
v_and_or_b32 v9, v9, v5, s55
v_and_or_b32 v10, v10, v5, s56
v_and_or_b32 v11, v11, v5, s57
global_store_dwordx4 v1, v[8:11], s[26:27] sc1
s_endpgm
.p2align 3
L_LN:
s_setprio 3
v_lshrrev_b32 v1, 4, v0
v_mul_u32_u24 v1, 1152, v1
v_and_b32 v3, 15, v0
v_lshl_add_u32 v2, v3, 3, v1
v_lshl_add_u32 v1, v3, 4, v1
s_waitcnt lgkmcnt(0)
s_cmp_ge_u32 s30, 25
s_cbranch_scc1 L_ib
s_barrier
L_ib:
global_load_dwordx4 v[10:13], v1, s[4:5] offset:0
global_load_dwordx4 v[14:17], v1, s[4:5] offset:256
global_load_dwordx4 v[18:21], v1, s[4:5] offset:512
global_load_dwordx4 v[22:25], v1, s[4:5] offset:768
global_load_dwordx2 v[26:27], v2, s[4:5] offset:1024
s_load_dword s28, s[26:27], 0
v_mov_b32 v8, 0
ds_write_b32 v8, v8 offset:23040
ds_write_b32 v8, v8 offset:23044
s_and_b32 s33, s2, 7
s_lshl_b32 s49, s33, 11
s_add_u32 s49, s49, 409600
s_lshl_b32 s33, s30, 7
s_add_u32 s33, s33, s49
s_sub_u32 s33, s33, 2048
v_lshl_add_u32 v9, v0, 4, s33
s_getreg_b32 s50, hwreg(HW_REG_XCC_ID, 0, 4)
s_lshl_b32 s50, s50, 8
v_mov_b32 v3, s50
s_waitcnt lgkmcnt(0)
s_and_b32 s29, s28, 0x7f7f7f7f
s_add_u32 s29, s29, 0x07050301
s_and_b32 s28, s28, 0x80808080
s_xor_b32 s29, s29, s28
s_and_b32 s54, s29, 0xff
s_bfe_u32 s55, s29, 0x80008
s_bfe_u32 s56, s29, 0x80010
s_lshr_b32 s57, s29, 24
v_or_b32 v68, s54, v3
v_or_b32 v69, s55, v3
v_or_b32 v70, s56, v3
v_or_b32 v71, s57, v3
s_mov_b64 exec, 0xff
global_store_dwordx4 v9, v[68:71], s[26:27]
s_mov_b64 exec, -1
s_mov_b32 s33, 0x3ae38e39
s_mov_b32 s34, 0xffff0000
s_waitcnt vmcnt(1)
v_lshlrev_b32 v30, 16, v10
v_and_b32 v31, s34, v10
v_lshlrev_b32 v32, 16, v11
v_and_b32 v33, s34, v11
v_lshlrev_b32 v34, 16, v12
v_and_b32 v35, s34, v12
v_lshlrev_b32 v36, 16, v13
v_and_b32 v37, s34, v13
v_lshlrev_b32 v38, 16, v14
v_and_b32 v39, s34, v14
v_lshlrev_b32 v40, 16, v15
v_and_b32 v41, s34, v15
v_lshlrev_b32 v42, 16, v16
v_and_b32 v43, s34, v16
v_lshlrev_b32 v44, 16, v17
v_and_b32 v45, s34, v17
v_lshlrev_b32 v46, 16, v18
v_and_b32 v47, s34, v18
v_lshlrev_b32 v48, 16, v19
v_and_b32 v49, s34, v19
v_lshlrev_b32 v50, 16, v20
v_and_b32 v51, s34, v20
v_lshlrev_b32 v52, 16, v21
v_and_b32 v53, s34, v21
v_lshlrev_b32 v54, 16, v22
v_and_b32 v55, s34, v22
v_lshlrev_b32 v56, 16, v23
v_and_b32 v57, s34, v23
v_lshlrev_b32 v58, 16, v24
v_and_b32 v59, s34, v24
v_lshlrev_b32 v60, 16, v25
v_and_b32 v61, s34, v25
v_lshlrev_b32 v62, 16, v26
v_and_b32 v63, s34, v26
v_lshlrev_b32 v64, 16, v27
v_and_b32 v65, s34, v27
v_pk_add_f32 v[4:5], v[30:31], v[32:33]
v_pk_add_f32 v[4:5], v[4:5], v[34:35]
v_pk_add_f32 v[4:5], v[4:5], v[36:37]
v_pk_add_f32 v[4:5], v[4:5], v[38:39]
v_pk_add_f32 v[4:5], v[4:5], v[40:41]
v_pk_add_f32 v[4:5], v[4:5], v[42:43]
v_pk_add_f32 v[4:5], v[4:5], v[44:45]
v_pk_add_f32 v[4:5], v[4:5], v[46:47]
v_pk_add_f32 v[4:5], v[4:5], v[48:49]
v_pk_add_f32 v[4:5], v[4:5], v[50:51]
v_pk_add_f32 v[4:5], v[4:5], v[52:53]
v_pk_add_f32 v[4:5], v[4:5], v[54:55]
v_pk_add_f32 v[4:5], v[4:5], v[56:57]
v_pk_add_f32 v[4:5], v[4:5], v[58:59]
v_pk_add_f32 v[4:5], v[4:5], v[60:61]
v_pk_add_f32 v[4:5], v[4:5], v[62:63]
v_pk_add_f32 v[4:5], v[4:5], v[64:65]
v_add_f32 v4, v4, v5
s_nop 1
v_add_f32_dpp v4, v4, v4 row_ror:8 row_mask:0xf bank_mask:0xf
s_nop 1
v_add_f32_dpp v4, v4, v4 row_ror:4 row_mask:0xf bank_mask:0xf
s_nop 1
v_add_f32_dpp v4, v4, v4 row_ror:2 row_mask:0xf bank_mask:0xf
s_nop 1
v_add_f32_dpp v4, v4, v4 row_ror:1 row_mask:0xf bank_mask:0xf
v_mul_f32 v4, s33, v4
v_pk_add_f32 v[10:11], v[30:31], v[4:5] op_sel_hi:[1,0] neg_lo:[0,1] neg_hi:[0,1]
v_pk_mul_f32 v[6:7], v[10:11], v[10:11]
v_pk_add_f32 v[10:11], v[32:33], v[4:5] op_sel_hi:[1,0] neg_lo:[0,1] neg_hi:[0,1]
v_pk_fma_f32 v[6:7], v[10:11], v[10:11], v[6:7]
v_pk_add_f32 v[10:11], v[34:35], v[4:5] op_sel_hi:[1,0] neg_lo:[0,1] neg_hi:[0,1]
v_pk_fma_f32 v[6:7], v[10:11], v[10:11], v[6:7]
v_pk_add_f32 v[10:11], v[36:37], v[4:5] op_sel_hi:[1,0] neg_lo:[0,1] neg_hi:[0,1]
v_pk_fma_f32 v[6:7], v[10:11], v[10:11], v[6:7]
v_pk_add_f32 v[10:11], v[38:39], v[4:5] op_sel_hi:[1,0] neg_lo:[0,1] neg_hi:[0,1]
v_pk_fma_f32 v[6:7], v[10:11], v[10:11], v[6:7]
v_pk_add_f32 v[10:11], v[40:41], v[4:5] op_sel_hi:[1,0] neg_lo:[0,1] neg_hi:[0,1]
v_pk_fma_f32 v[6:7], v[10:11], v[10:11], v[6:7]
v_pk_add_f32 v[10:11], v[42:43], v[4:5] op_sel_hi:[1,0] neg_lo:[0,1] neg_hi:[0,1]
v_pk_fma_f32 v[6:7], v[10:11], v[10:11], v[6:7]
v_pk_add_f32 v[10:11], v[44:45], v[4:5] op_sel_hi:[1,0] neg_lo:[0,1] neg_hi:[0,1]
v_pk_fma_f32 v[6:7], v[10:11], v[10:11], v[6:7]
v_pk_add_f32 v[10:11], v[46:47], v[4:5] op_sel_hi:[1,0] neg_lo:[0,1] neg_hi:[0,1]
v_pk_fma_f32 v[6:7], v[10:11], v[10:11], v[6:7]
v_pk_add_f32 v[10:11], v[48:49], v[4:5] op_sel_hi:[1,0] neg_lo:[0,1] neg_hi:[0,1]
v_pk_fma_f32 v[6:7], v[10:11], v[10:11], v[6:7]
v_pk_add_f32 v[10:11], v[50:51], v[4:5] op_sel_hi:[1,0] neg_lo:[0,1] neg_hi:[0,1]
v_pk_fma_f32 v[6:7], v[10:11], v[10:11], v[6:7]
v_pk_add_f32 v[10:11], v[52:53], v[4:5] op_sel_hi:[1,0] neg_lo:[0,1] neg_hi:[0,1]
v_pk_fma_f32 v[6:7], v[10:11], v[10:11], v[6:7]
v_pk_add_f32 v[10:11], v[54:55], v[4:5] op_sel_hi:[1,0] neg_lo:[0,1] neg_hi:[0,1]
v_pk_fma_f32 v[6:7], v[10:11], v[10:11], v[6:7]
v_pk_add_f32 v[10:11], v[56:57], v[4:5] op_sel_hi:[1,0] neg_lo:[0,1] neg_hi:[0,1]
v_pk_fma_f32 v[6:7], v[10:11], v[10:11], v[6:7]
v_pk_add_f32 v[10:11], v[58:59], v[4:5] op_sel_hi:[1,0] neg_lo:[0,1] neg_hi:[0,1]
v_pk_fma_f32 v[6:7], v[10:11], v[10:11], v[6:7]
v_pk_add_f32 v[10:11], v[60:61], v[4:5] op_sel_hi:[1,0] neg_lo:[0,1] neg_hi:[0,1]
v_pk_fma_f32 v[6:7], v[10:11], v[10:11], v[6:7]
v_pk_add_f32 v[10:11], v[62:63], v[4:5] op_sel_hi:[1,0] neg_lo:[0,1] neg_hi:[0,1]
v_pk_fma_f32 v[6:7], v[10:11], v[10:11], v[6:7]
v_pk_add_f32 v[10:11], v[64:65], v[4:5] op_sel_hi:[1,0] neg_lo:[0,1] neg_hi:[0,1]
v_pk_fma_f32 v[6:7], v[10:11], v[10:11], v[6:7]
v_add_f32 v6, v6, v7
s_nop 1
v_add_f32_dpp v6, v6, v6 row_ror:8 row_mask:0xf bank_mask:0xf
s_nop 1
v_add_f32_dpp v6, v6, v6 row_ror:4 row_mask:0xf bank_mask:0xf
s_nop 1
v_add_f32_dpp v6, v6, v6 row_ror:2 row_mask:0xf bank_mask:0xf
s_nop 1
v_add_f32_dpp v6, v6, v6 row_ror:1 row_mask:0xf bank_mask:0xf
v_mul_f32 v6, s33, v6
v_cvt_pk_bf16_f32 v4, 0, v4
v_cvt_pk_bf16_f32 v6, 0, v6
v_add_f32 v6, 0x3727c5ac, v6
v_cvt_pk_bf16_f32 v6, 0, v6
v_sqrt_f32 v6, v6
s_nop 0
v_cvt_pk_bf16_f32 v6, 0, v6
v_rcp_f32 v6, v6
v_pk_add_f32 v[30:31], v[30:31], v[4:5] op_sel_hi:[1,0] neg_lo:[0,1] neg_hi:[0,1]
v_pk_add_f32 v[32:33], v[32:33], v[4:5] op_sel_hi:[1,0] neg_lo:[0,1] neg_hi:[0,1]
v_pk_add_f32 v[34:35], v[34:35], v[4:5] op_sel_hi:[1,0] neg_lo:[0,1] neg_hi:[0,1]
v_pk_add_f32 v[36:37], v[36:37], v[4:5] op_sel_hi:[1,0] neg_lo:[0,1] neg_hi:[0,1]
v_pk_add_f32 v[38:39], v[38:39], v[4:5] op_sel_hi:[1,0] neg_lo:[0,1] neg_hi:[0,1]
v_pk_add_f32 v[40:41], v[40:41], v[4:5] op_sel_hi:[1,0] neg_lo:[0,1] neg_hi:[0,1]
v_pk_add_f32 v[42:43], v[42:43], v[4:5] op_sel_hi:[1,0] neg_lo:[0,1] neg_hi:[0,1]
v_pk_add_f32 v[44:45], v[44:45], v[4:5] op_sel_hi:[1,0] neg_lo:[0,1] neg_hi:[0,1]
v_pk_add_f32 v[46:47], v[46:47], v[4:5] op_sel_hi:[1,0] neg_lo:[0,1] neg_hi:[0,1]
v_pk_add_f32 v[48:49], v[48:49], v[4:5] op_sel_hi:[1,0] neg_lo:[0,1] neg_hi:[0,1]
v_pk_add_f32 v[50:51], v[50:51], v[4:5] op_sel_hi:[1,0] neg_lo:[0,1] neg_hi:[0,1]
v_pk_add_f32 v[52:53], v[52:53], v[4:5] op_sel_hi:[1,0] neg_lo:[0,1] neg_hi:[0,1]
v_pk_add_f32 v[54:55], v[54:55], v[4:5] op_sel_hi:[1,0] neg_lo:[0,1] neg_hi:[0,1]
v_pk_add_f32 v[56:57], v[56:57], v[4:5] op_sel_hi:[1,0] neg_lo:[0,1] neg_hi:[0,1]
v_pk_add_f32 v[58:59], v[58:59], v[4:5] op_sel_hi:[1,0] neg_lo:[0,1] neg_hi:[0,1]
v_pk_add_f32 v[60:61], v[60:61], v[4:5] op_sel_hi:[1,0] neg_lo:[0,1] neg_hi:[0,1]
v_pk_add_f32 v[62:63], v[62:63], v[4:5] op_sel_hi:[1,0] neg_lo:[0,1] neg_hi:[0,1]
v_pk_add_f32 v[64:65], v[64:65], v[4:5] op_sel_hi:[1,0] neg_lo:[0,1] neg_hi:[0,1]
v_cvt_pk_bf16_f32 v30, 0, v30
v_cvt_pk_bf16_f32 v31, 0, v31
v_cvt_pk_bf16_f32 v32, 0, v32
v_cvt_pk_bf16_f32 v33, 0, v33
v_cvt_pk_bf16_f32 v34, 0, v34
v_cvt_pk_bf16_f32 v35, 0, v35
v_cvt_pk_bf16_f32 v36, 0, v36
v_cvt_pk_bf16_f32 v37, 0, v37
v_cvt_pk_bf16_f32 v38, 0, v38
v_cvt_pk_bf16_f32 v39, 0, v39
v_cvt_pk_bf16_f32 v40, 0, v40
v_cvt_pk_bf16_f32 v41, 0, v41
v_cvt_pk_bf16_f32 v42, 0, v42
v_cvt_pk_bf16_f32 v43, 0, v43
v_cvt_pk_bf16_f32 v44, 0, v44
v_cvt_pk_bf16_f32 v45, 0, v45
v_cvt_pk_bf16_f32 v46, 0, v46
v_cvt_pk_bf16_f32 v47, 0, v47
v_cvt_pk_bf16_f32 v48, 0, v48
v_cvt_pk_bf16_f32 v49, 0, v49
v_cvt_pk_bf16_f32 v50, 0, v50
v_cvt_pk_bf16_f32 v51, 0, v51
v_cvt_pk_bf16_f32 v52, 0, v52
v_cvt_pk_bf16_f32 v53, 0, v53
v_cvt_pk_bf16_f32 v54, 0, v54
v_cvt_pk_bf16_f32 v55, 0, v55
v_cvt_pk_bf16_f32 v56, 0, v56
v_cvt_pk_bf16_f32 v57, 0, v57
v_cvt_pk_bf16_f32 v58, 0, v58
v_cvt_pk_bf16_f32 v59, 0, v59
v_cvt_pk_bf16_f32 v60, 0, v60
v_cvt_pk_bf16_f32 v61, 0, v61
v_cvt_pk_bf16_f32 v62, 0, v62
v_cvt_pk_bf16_f32 v63, 0, v63
v_cvt_pk_bf16_f32 v64, 0, v64
v_cvt_pk_bf16_f32 v65, 0, v65
v_pk_mul_f32 v[30:31], v[30:31], v[6:7] op_sel_hi:[1,0]
v_pk_mul_f32 v[32:33], v[32:33], v[6:7] op_sel_hi:[1,0]
v_pk_mul_f32 v[34:35], v[34:35], v[6:7] op_sel_hi:[1,0]
v_pk_mul_f32 v[36:37], v[36:37], v[6:7] op_sel_hi:[1,0]
v_pk_mul_f32 v[38:39], v[38:39], v[6:7] op_sel_hi:[1,0]
v_pk_mul_f32 v[40:41], v[40:41], v[6:7] op_sel_hi:[1,0]
v_pk_mul_f32 v[42:43], v[42:43], v[6:7] op_sel_hi:[1,0]
v_pk_mul_f32 v[44:45], v[44:45], v[6:7] op_sel_hi:[1,0]
v_pk_mul_f32 v[46:47], v[46:47], v[6:7] op_sel_hi:[1,0]
v_pk_mul_f32 v[48:49], v[48:49], v[6:7] op_sel_hi:[1,0]
v_pk_mul_f32 v[50:51], v[50:51], v[6:7] op_sel_hi:[1,0]
v_pk_mul_f32 v[52:53], v[52:53], v[6:7] op_sel_hi:[1,0]
v_pk_mul_f32 v[54:55], v[54:55], v[6:7] op_sel_hi:[1,0]
v_pk_mul_f32 v[56:57], v[56:57], v[6:7] op_sel_hi:[1,0]
v_pk_mul_f32 v[58:59], v[58:59], v[6:7] op_sel_hi:[1,0]
v_pk_mul_f32 v[60:61], v[60:61], v[6:7] op_sel_hi:[1,0]
v_pk_mul_f32 v[62:63], v[62:63], v[6:7] op_sel_hi:[1,0]
v_pk_mul_f32 v[64:65], v[64:65], v[6:7] op_sel_hi:[1,0]
v_cvt_pk_bf16_f32 v10, v30, v31
v_cvt_pk_bf16_f32 v11, v32, v33
v_cvt_pk_bf16_f32 v12, v34, v35
v_cvt_pk_bf16_f32 v13, v36, v37
v_cvt_pk_bf16_f32 v14, v38, v39
v_cvt_pk_bf16_f32 v15, v40, v41
v_cvt_pk_bf16_f32 v16, v42, v43
v_cvt_pk_bf16_f32 v17, v44, v45
v_cvt_pk_bf16_f32 v18, v46, v47
v_cvt_pk_bf16_f32 v19, v48, v49
v_cvt_pk_bf16_f32 v20, v50, v51
v_cvt_pk_bf16_f32 v21, v52, v53
v_cvt_pk_bf16_f32 v22, v54, v55
v_cvt_pk_bf16_f32 v23, v56, v57
v_cvt_pk_bf16_f32 v24, v58, v59
v_cvt_pk_bf16_f32 v25, v60, v61
v_cvt_pk_bf16_f32 v26, v62, v63
v_cvt_pk_bf16_f32 v27, v64, v65
ds_write_b128 v1, v[10:13] offset:0
ds_write_b128 v1, v[14:17] offset:256
ds_write_b128 v1, v[18:21] offset:512
ds_write_b128 v1, v[22:25] offset:768
ds_write_b64 v2, v[26:27] offset:1024
s_waitcnt lgkmcnt(0)
s_barrier
s_cmp_ge_u32 s30, 25
s_cbranch_scc1 L_fin
s_and_b32 s32, s2, 7
s_mul_i32 s32, s32, 9
s_add_u32 s32, s32, s30
s_sub_u32 s32, s32, 16
v_lshrrev_b32 v3, 2, v0
v_min_u32 v3, 8, v3
v_lshl_add_u32 v3, v3, 7, s49
v_and_b32 v4, 3, v0
v_lshl_add_u32 v3, v4, 4, v3
global_load_dwordx4 v[4:7], v3, s[26:27] sc1
v_bfe_u32 v1, v0, 2, 2
v_mul_u32_u24 v1, 128, v1
v_bfe_u32 v2, v0, 1, 1
v_lshl_add_u32 v1, v2, 6, v1
v_and_b32 v2, 48, v0
v_add_u32 v1, v1, v2
v_and_b32 v2, 1, v0
v_lshlrev_b32 v2, 4, v2
v_lshl_add_u32 v1, v1, 1, v2
s_lshl_b32 s33, s32, 10
s_add_u32 s33, s33, 425984
v_lshl_add_u32 v2, v0, 4, s33
s_lshr_b32 s35, s16, 7
s_add_u32 s35, s35, s32
s_and_b32 s35, s35, 7
s_cmp_lg_u32 s35, 3
s_cbranch_scc1 L_hn
s_barrier
L_hn:
s_mov_b32 s34, 0x3d372713
s_mov_b32 s35, 0xc0135761
s_setprio 0
s_waitcnt vmcnt(0)
v_xor_b32 v4, v68, v4
v_xor_b32 v5, v69, v5
v_xor_b32 v6, v70, v6
v_xor_b32 v7, v71, v7
v_or3_b32 v4, v4, v5, v6
v_or_b32 v4, v4, v7
v_cmp_ne_u32 s[44:45], 0, v4
s_mov_b32 s51, 4194304
L_spin22:
ds_read_b32 v4, v8 offset:23044
s_sub_u32 s51, s51, 1
s_waitcnt lgkmcnt(0)
s_cbranch_scc1 L_spinx23
v_cmp_ne_u32 vcc, 9, v4
s_cbranch_vccnz L_spin22
L_spinx23:
ds_read_b128 v[12:15], v1 offset:4608
ds_read_b128 v[16:19], v1 offset:6656
ds_read_b128 v[20:23], v1 offset:8704
ds_read_b128 v[24:27], v1 offset:10752
ds_read_b128 v[28:31], v1 offset:12800
ds_read_b128 v[32:35], v1 offset:14848
ds_read_b128 v[36:39], v1 offset:16896
ds_read_b128 v[40:43], v1 offset:18944
ds_read_b128 v[44:47], v1 offset:20992
s_waitcnt lgkmcnt(0)
v_pk_add_f32 v[12:13], v[12:13], v[28:29]
v_pk_add_f32 v[14:15], v[14:15], v[30:31]
v_pk_add_f32 v[16:17], v[16:17], v[32:33]
v_pk_add_f32 v[18:19], v[18:19], v[34:35]
v_pk_add_f32 v[20:21], v[20:21], v[36:37]
v_pk_add_f32 v[22:23], v[22:23], v[38:39]
v_pk_add_f32 v[24:25], v[24:25], v[40:41]
v_pk_add_f32 v[26:27], v[26:27], v[42:43]
v_pk_add_f32 v[12:13], v[12:13], v[20:21]
v_pk_add_f32 v[14:15], v[14:15], v[22:23]
v_pk_add_f32 v[16:17], v[16:17], v[24:25]
v_pk_add_f32 v[18:19], v[18:19], v[26:27]
v_pk_add_f32 v[12:13], v[12:13], v[44:45]
v_pk_add_f32 v[14:15], v[14:15], v[46:47]
v_pk_add_f32 v[12:13], v[12:13], v[16:17]
v_pk_add_f32 v[14:15], v[14:15], v[18:19]
v_cvt_pk_bf16_f32 v12, 0, v12
v_cvt_pk_bf16_f32 v13, 0, v13
v_cvt_pk_bf16_f32 v14, 0, v14
v_cvt_pk_bf16_f32 v15, 0, v15
v_mul_f32 v16, v12, v12
v_mul_f32 v17, v13, v13
v_mul_f32 v18, v14, v14
v_mul_f32 v19, v15, v15
v_mul_f32 v16, v16, v12
v_mul_f32 v17, v17, v13
v_mul_f32 v18, v18, v14
v_mul_f32 v19, v19, v15
v_fma_f32 v16, s34, v16, v12
v_fma_f32 v17, s34, v17, v13
v_fma_f32 v18, s34, v18, v14
v_fma_f32 v19, s34, v19, v15
v_mul_f32 v16, s35, v16
v_mul_f32 v17, s35, v17
v_mul_f32 v18, s35, v18
v_mul_f32 v19, s35, v19
v_exp_f32 v16, v16
v_exp_f32 v17, v17
v_exp_f32 v18, v18
v_exp_f32 v19, v19
v_add_f32 v16, 1.0, v16
v_add_f32 v17, 1.0, v17
v_add_f32 v18, 1.0, v18
v_add_f32 v19, 1.0, v19
v_rcp_f32 v16, v16
v_rcp_f32 v17, v17
v_rcp_f32 v18, v18
v_rcp_f32 v19, v19
v_mul_f32 v12, v12, v16
v_mul_f32 v13, v13, v17
v_mul_f32 v14, v14, v18
v_mul_f32 v15, v15, v19
v_cvt_pk_bf16_f32 v12, 0, v12
v_cvt_pk_bf16_f32 v13, 0, v13
v_cvt_pk_bf16_f32 v14, 0, v14
v_cvt_pk_bf16_f32 v15, 0, v15
s_mov_b32 s51, 4194304
L_spin24:
ds_read_b32 v4, v8 offset:23040
s_sub_u32 s51, s51, 1
s_waitcnt lgkmcnt(0)
s_cbranch_scc1 L_spinx25
v_cmp_ne_u32 vcc, 9, v4
s_cbranch_vccnz L_spin24
L_spinx25:
s_setprio 3
ds_read_b128 v[48:51], v1 offset:5632
ds_read_b128 v[52:55], v1 offset:7680
ds_read_b128 v[56:59], v1 offset:9728
ds_read_b128 v[60:63], v1 offset:11776
ds_read_b128 v[64:67], v1 offset:13824
ds_read_b128 v[68:71], v1 offset:15872
ds_read_b128 v[72:75], v1 offset:17920
ds_read_b128 v[76:79], v1 offset:19968
ds_read_b128 v[80:83], v1 offset:22016
s_waitcnt lgkmcnt(0)
v_pk_add_f32 v[48:49], v[48:49], v[64:65]
v_pk_add_f32 v[50:51], v[50:51], v[66:67]
v_pk_add_f32 v[52:53], v[52:53], v[68:69]
v_pk_add_f32 v[54:55], v[54:55], v[70:71]
v_pk_add_f32 v[56:57], v[56:57], v[72:73]
v_pk_add_f32 v[58:59], v[58:59], v[74:75]
v_pk_add_f32 v[60:61], v[60:61], v[76:77]
v_pk_add_f32 v[62:63], v[62:63], v[78:79]
v_pk_add_f32 v[48:49], v[48:49], v[56:57]
v_pk_add_f32 v[50:51], v[50:51], v[58:59]
v_pk_add_f32 v[52:53], v[52:53], v[60:61]
v_pk_add_f32 v[54:55], v[54:55], v[62:63]
v_pk_add_f32 v[48:49], v[48:49], v[80:81]
v_pk_add_f32 v[50:51], v[50:51], v[82:83]
v_pk_add_f32 v[48:49], v[48:49], v[52:53]
v_pk_add_f32 v[50:51], v[50:51], v[54:55]
v_cvt_pk_bf16_f32 v48, 0, v48
v_cvt_pk_bf16_f32 v49, 0, v49
v_cvt_pk_bf16_f32 v50, 0, v50
v_cvt_pk_bf16_f32 v51, 0, v51
v_pk_mul_f32 v[12:13], v[12:13], v[48:49]
v_pk_mul_f32 v[14:15], v[14:15], v[50:51]
v_cvt_pk_bf16_f32 v12, 0, v12
v_cvt_pk_bf16_f32 v13, 0, v13
v_cvt_pk_bf16_f32 v14, 0, v14
v_cvt_pk_bf16_f32 v15, 0, v15
v_or_b32 v12, s54, v12
v_or_b32 v13, s55, v13
v_or_b32 v14, s56, v14
v_or_b32 v15, s57, v15
s_cmp_lg_u64 s[44:45], 0
s_cbranch_scc1 L_far26
global_store_dwordx4 v2, v[12:15], s[26:27]
L_pub27:
s_endpgm
L_H:
s_cmp_ge_u32 s30, 32
s_cbranch_scc1 L_exit
s_cmp_ge_u32 s3, 9
s_cbranch_scc1 L_exit
v_lshrrev_b32 v1, 3, v0
v_mul_u32_u24 v1, 9216, v1
v_and_b32 v2, 7, v0
v_lshl_add_u32 v1, v2, 4, v1
s_mov_b32 s38, 5308416
s_mov_b32 s39, 0x20000
s_and_b32 s32, s2, 7
s_mov_b32 s33, 8
s_waitcnt lgkmcnt(0)
s_mov_b64 s[36:37], s[18:19]
s_lshr_b32 s35, s16, 7
s_add_u32 s35, s35, s32
s_and_b32 s35, s35, 7
s_sub_u32 s35, 3, s35
s_and_b32 s35, s35, 7
s_mul_i32 s32, s32, 9
s_add_u32 s32, s32, s35
s_mul_i32 s48, s3, 576
s_add_u32 s48, s48, s32
s_lshl_b32 s48, s48, 7
L_Hl:
s_waitcnt vmcnt(2)
buffer_load_dwordx4 v[4:7], v1, s[36:39], s48 offen
s_add_u32 s48, s48, 663552
s_sub_u32 s33, s33, 1
s_cmp_lg_u32 s33, 0
s_cbranch_scc1 L_Hl
s_endpgm
L_B:
s_and_b32 s32, s2, 7
s_mul_i32 s32, s32, 9
s_add_u32 s32, s32, s30
s_sub_u32 s32, s32, 16
s_mul_i32 s48, s3, 576
s_add_u32 s48, s48, s32
s_lshl_b32 s48, s48, 7
s_mov_b32 s49, s48
s_mov_b32 s61, 663552
v_bfe_u32 v1, v0, 3, 1
v_lshrrev_b32 v2, 4, v0
v_lshl_add_u32 v1, v1, 2, v2
v_mul_u32_u24 v1, 9216, v1
v_and_b32 v2, 7, v0
v_lshl_add_u32 v1, v2, 4, v1
s_mov_b32 s38, 5308416
s_mov_b32 s39, 0x20000
s_waitcnt lgkmcnt(0)
s_mov_b64 s[36:37], s[16:17]
s_lshr_b32 s35, s16, 7
s_add_u32 s35, s35, s32
s_and_b32 s35, s35, 7
s_cmp_eq_u32 s35, 3
s_cbranch_scc1 L_Bs
buffer_load_dwordx4 v[40:43], v1, s[36:39], s48 offen nt
s_add_u32 s48, s48, s61
s_barrier
buffer_load_dwordx4 v[44:47], v1, s[36:39], s48 offen nt
s_add_u32 s48, s48, s61
s_waitcnt vmcnt(1)
buffer_load_dwordx4 v[48:51], v1, s[36:39], s48 offen nt
s_add_u32 s48, s48, s61
s_waitcnt vmcnt(1)
buffer_load_dwordx4 v[52:55], v1, s[36:39], s48 offen nt
s_add_u32 s48, s48, s61
s_load_dword s28, s[26:27], 0
s_mov_b64 s[40:41], s[18:19]
s_mov_b32 s42, 5308416
s_mov_b32 s43, 0x20000
s_mov_b64 s[44:45], s[20:21]
s_mov_b32 s46, 5308416
s_mov_b32 s47, 0x20000
s_sub_u32 s60, s30, 16
s_sub_u32 s62, s32, s60
s_add_u32 s62, s62, s3
s_mul_i32 s50, s62, 576
s_add_u32 s50, s50, s60
s_lshl_b32 s50, s50, 7
s_lshl_b32 s33, s3, 7
s_waitcnt vmcnt(1)
buffer_load_dwordx4 v[56:59], v1, s[36:39], s48 offen nt
s_add_u32 s48, s48, s61
v_and_b32 v2, 8, v0
v_lshrrev_b32 v3, 4, v0
v_or_b32 v2, v2, v3
v_mul_u32_u24 v2, 4608, v2
v_and_b32 v3, 7, v0
v_lshl_add_u32 v2, v3, 4, v2
v_bfe_u32 v3, v0, 2, 2
v_lshrrev_b32 v4, 5, v0
v_lshl_add_u32 v3, v3, 1, v4
v_mul_u32_u24 v3, 576, v3
v_bfe_u32 v4, v0, 4, 1
v_and_or_b32 v4, v0, 2, v4
v_lshl_add_u32 v3, v4, 2, v3
s_lshl_b32 s33, s3, 4
s_mov_b32 s52, 0x07060302
s_mov_b32 s53, 0x05040100
v_add_u32 v3, s33, v3
v_pk_mov_b32 v[136:137], v[40:41], v[44:45] op_sel:[0,0]
v_pk_mov_b32 v[144:145], v[40:41], v[44:45] op_sel:[1,1]
v_pk_mov_b32 v[152:153], v[42:43], v[46:47] op_sel:[0,0]
v_pk_mov_b32 v[160:161], v[42:43], v[46:47] op_sel:[1,1]
s_waitcnt vmcnt(1)
buffer_load_dwordx4 v[60:63], v1, s[36:39], s48 offen nt
s_add_u32 s48, s48, s61
v_and_b32 v24, 1, v0
v_mul_u32_u24 v24, 0x5555, v24
v_or_b32 v24, 0x8888, v24
v_mov_b64 v[8:9], 0
v_mov_b64 v[10:11], 0
v_mov_b64 v[12:13], 0
v_mov_b64 v[14:15], 0
v_mov_b64 v[16:17], 0
v_mov_b64 v[18:19], 0
v_mov_b64 v[20:21], 0
v_mov_b64 v[22:23], 0
v_pk_mov_b32 v[138:139], v[48:49], v[52:53] op_sel:[0,0]
v_pk_mov_b32 v[146:147], v[48:49], v[52:53] op_sel:[1,1]
v_pk_mov_b32 v[154:155], v[50:51], v[54:55] op_sel:[0,0]
v_pk_mov_b32 v[162:163], v[50:51], v[54:55] op_sel:[1,1]
s_waitcnt vmcnt(1)
buffer_load_dwordx4 v[64:67], v1, s[36:39], s48 offen nt
s_add_u32 s48, s48, s61
s_waitcnt lgkmcnt(0)
s_and_b32 s29, s28, 0x7f7f7f7f
s_add_u32 s29, s29, 0x07050301
s_and_b32 s28, s28, 0x80808080
s_xor_b32 s29, s29, s28
s_and_b32 s54, s29, 0xff
s_bfe_u32 s55, s29, 0x80008
s_bfe_u32 s56, s29, 0x80010
s_lshr_b32 s57, s29, 24
s_barrier
ds_read2_b32 v[30:31], v3 offset1:36
ds_read2_b32 v[32:33], v3 offset0:72 offset1:108
s_waitcnt vmcnt(1)
buffer_load_dwordx4 v[68:71], v1, s[36:39], s48 offen nt
v_pk_mov_b32 v[140:141], v[56:57], v[60:61] op_sel:[0,0]
v_pk_mov_b32 v[148:149], v[56:57], v[60:61] op_sel:[1,1]
v_pk_mov_b32 v[156:157], v[58:59], v[62:63] op_sel:[0,0]
v_pk_mov_b32 v[164:165], v[58:59], v[62:63] op_sel:[1,1]
s_waitcnt vmcnt(1)
buffer_load_dwordx4 v[72:75], v1, s[40:43], s49 offen nt
s_add_u32 s49, s49, s61
buffer_load_dwordx4 v[76:79], v1, s[40:43], s49 offen nt
s_add_u32 s49, s49, s61
s_waitcnt vmcnt(2)
buffer_load_dwordx4 v[80:83], v1, s[40:43], s49 offen nt
s_add_u32 s49, s49, s61
v_pk_mov_b32 v[142:143], v[64:65], v[68:69] op_sel:[0,0]
v_pk_mov_b32 v[150:151], v[64:65], v[68:69] op_sel:[1,1]
v_pk_mov_b32 v[158:159], v[66:67], v[70:71] op_sel:[0,0]
v_pk_mov_b32 v[166:167], v[66:67], v[70:71] op_sel:[1,1]
s_waitcnt lgkmcnt(0)
v_perm_b32 v4, v31, v30, s53
v_perm_b32 v5, v33, v32, s53
v_perm_b32 v6, v31, v30, s52
v_perm_b32 v7, v33, v32, s52
s_nop 1
v_smfmac_f32_16x16x64_bf16 v[8:11], v[4:7], v[136:143], v24
v_smfmac_f32_16x16x64_bf16 v[12:15], v[4:7], v[144:151], v24
v_smfmac_f32_16x16x64_bf16 v[16:19], v[4:7], v[152:159], v24
v_smfmac_f32_16x16x64_bf16 v[20:23], v[4:7], v[160:167], v24
v_lshrrev_b32 v3, 4, v0
v_mul_u32_u24 v3, 256, v3
v_and_b32 v44, 7, v0
v_lshl_add_u32 v3, v44, 5, v3
v_and_b32 v44, 8, v0
v_lshl_add_u32 v3, v44, 1, v3
s_lshl_b32 s34, s3, 11
v_add_u32 v3, s34, v3
v_mov_b32 v34, 1
v_mov_b32 v35, 23040
v_add_f32_dpp v40, v10, v8 row_ror:8 row_mask:0xf bank_mask:0x3
v_add_f32_dpp v41, v11, v9 row_ror:8 row_mask:0xf bank_mask:0x3
v_add_f32_dpp v42, v14, v12 row_ror:8 row_mask:0xf bank_mask:0x3
v_add_f32_dpp v43, v15, v13 row_ror:8 row_mask:0xf bank_mask:0x3
v_add_f32_dpp v40, v16, v18 row_ror:8 row_mask:0xf bank_mask:0xc
v_add_f32_dpp v41, v17, v19 row_ror:8 row_mask:0xf bank_mask:0xc
v_add_f32_dpp v42, v20, v22 row_ror:8 row_mask:0xf bank_mask:0xc
v_add_f32_dpp v43, v21, v23 row_ror:8 row_mask:0xf bank_mask:0xc
ds_write_b128 v3, v[40:43] offset:4608
s_mov_b64 exec, 1
ds_add_u32 v35, v34 offset:4
s_mov_b64 exec, -1
v_mov_b64 v[8:9], 0
v_mov_b64 v[10:11], 0
v_mov_b64 v[12:13], 0
v_mov_b64 v[14:15], 0
v_mov_b64 v[16:17], 0
v_mov_b64 v[18:19], 0
v_mov_b64 v[20:21], 0
v_mov_b64 v[22:23], 0
s_waitcnt vmcnt(2)
buffer_load_dwordx4 v[84:87], v1, s[40:43], s49 offen nt
s_add_u32 s49, s49, s61
s_waitcnt vmcnt(2)
buffer_load_dwordx4 v[88:91], v1, s[40:43], s49 offen nt
s_add_u32 s49, s49, s61
s_lshl_b32 s33, s62, 10
s_add_u32 s33, s33, 425984
v_lshl_add_u32 v26, v0, 4, s33
s_mov_b32 s52, 0x07060302
s_and_b32 s33, s2, 7
s_mul_i32 s33, s33, 48
s_mul_i32 s34, s3, 9
s_add_u32 s33, s33, s34
s_add_u32 s33, s33, s60
s_lshl_b32 s33, s33, 8
s_add_u32 s33, s33, 524288
v_lshl_add_u32 v27, v0, 2, s33
v_pk_mov_b32 v[136:137], v[72:73], v[76:77] op_sel:[0,0]
v_pk_mov_b32 v[144:145], v[72:73], v[76:77] op_sel:[1,1]
v_pk_mov_b32 v[152:153], v[74:75], v[78:79] op_sel:[0,0]
v_pk_mov_b32 v[160:161], v[74:75], v[78:79] op_sel:[1,1]
s_waitcnt vmcnt(2)
buffer_load_dwordx4 v[92:95], v1, s[40:43], s49 offen nt
s_add_u32 s49, s49, s61
s_lshl_b32 s34, s3, 8
s_add_u32 s34, s34, 23552
v_lshl_add_u32 v28, v0, 2, s34
v_and_b32 v29, 3, v0
v_lshlrev_b32 v29, 3, v29
v_bfe_u32 v29, s29, v29, 8
s_mov_b32 s63, 0xffffff00
s_lshl_b32 s59, s3, 10
s_waitcnt vmcnt(2)
buffer_load_dwordx4 v[96:99], v1, s[40:43], s49 offen nt
s_add_u32 s49, s49, s61
v_pk_mov_b32 v[138:139], v[80:81], v[84:85] op_sel:[0,0]
v_pk_mov_b32 v[146:147], v[80:81], v[84:85] op_sel:[1,1]
v_pk_mov_b32 v[154:155], v[82:83], v[86:87] op_sel:[0,0]
v_pk_mov_b32 v[162:163], v[82:83], v[86:87] op_sel:[1,1]
s_waitcnt vmcnt(2)
buffer_load_dwordx4 v[100:103], v1, s[40:43], s49 offen nt
s_waitcnt vmcnt(2)
buffer_load_dwordx4 v[104:107], v2, s[44:47], s50 offen offset:0 nt
v_pk_mov_b32 v[140:141], v[88:89], v[92:93] op_sel:[0,0]
v_pk_mov_b32 v[148:149], v[88:89], v[92:93] op_sel:[1,1]
v_pk_mov_b32 v[156:157], v[90:91], v[94:95] op_sel:[0,0]
v_pk_mov_b32 v[164:165], v[90:91], v[94:95] op_sel:[1,1]
s_waitcnt vmcnt(2)
buffer_load_dwordx4 v[108:111], v2, s[44:47], s50 offen offset:1152 nt
s_waitcnt vmcnt(2)
buffer_load_dwordx4 v[112:115], v2, s[44:47], s50 offen offset:2304 nt
v_pk_mov_b32 v[142:143], v[96:97], v[100:101] op_sel:[0,0]
v_pk_mov_b32 v[150:151], v[96:97], v[100:101] op_sel:[1,1]
v_pk_mov_b32 v[158:159], v[98:99], v[102:103] op_sel:[0,0]
v_pk_mov_b32 v[166:167], v[98:99], v[102:103] op_sel:[1,1]
v_smfmac_f32_16x16x64_bf16 v[8:11], v[4:7], v[136:143], v24
v_smfmac_f32_16x16x64_bf16 v[12:15], v[4:7], v[144:151], v24
v_smfmac_f32_16x16x64_bf16 v[16:19], v[4:7], v[152:159], v24
v_smfmac_f32_16x16x64_bf16 v[20:23], v[4:7], v[160:167], v24
s_nop 4
v_add_f32_dpp v44, v10, v8 row_ror:8 row_mask:0xf bank_mask:0x3
v_add_f32_dpp v45, v11, v9 row_ror:8 row_mask:0xf bank_mask:0x3
v_add_f32_dpp v46, v14, v12 row_ror:8 row_mask:0xf bank_mask:0x3
v_add_f32_dpp v47, v15, v13 row_ror:8 row_mask:0xf bank_mask:0x3
v_add_f32_dpp v44, v16, v18 row_ror:8 row_mask:0xf bank_mask:0xc
v_add_f32_dpp v45, v17, v19 row_ror:8 row_mask:0xf bank_mask:0xc
v_add_f32_dpp v46, v20, v22 row_ror:8 row_mask:0xf bank_mask:0xc
v_add_f32_dpp v47, v21, v23 row_ror:8 row_mask:0xf bank_mask:0xc
ds_write_b128 v3, v[44:47] offset:5632
s_mov_b64 exec, 1
ds_add_u32 v35, v34
s_mov_b64 exec, -1
v_mov_b64 v[8:9], 0
v_mov_b64 v[10:11], 0
v_mov_b64 v[12:13], 0
v_mov_b64 v[14:15], 0
v_mov_b64 v[16:17], 0
v_mov_b64 v[18:19], 0
v_mov_b64 v[20:21], 0
v_mov_b64 v[22:23], 0
s_waitcnt vmcnt(2)
buffer_load_dwordx4 v[116:119], v2, s[44:47], s50 offen offset:3456 nt
s_add_u32 s50, s50, 18432
s_waitcnt vmcnt(2)
buffer_load_dwordx4 v[120:123], v2, s[44:47], s50 offen offset:0 nt
v_pk_mov_b32 v[136:137], v[104:105], v[108:109] op_sel:[0,0]
v_pk_mov_b32 v[144:145], v[104:105], v[108:109] op_sel:[1,1]
v_pk_mov_b32 v[152:153], v[106:107], v[110:111] op_sel:[0,0]
v_pk_mov_b32 v[160:161], v[106:107], v[110:111] op_sel:[1,1]
buffer_load_dwordx4 v[124:127], v2, s[44:47], s50 offen offset:1152 nt
s_waitcnt vmcnt(3)
buffer_load_dwordx4 v[128:131], v2, s[44:47], s50 offen offset:2304 nt
s_waitcnt vmcnt(3)
buffer_load_dwordx4 v[132:135], v2, s[44:47], s50 offen offset:3456 nt
v_pk_mov_b32 v[138:139], v[112:113], v[116:117] op_sel:[0,0]
v_pk_mov_b32 v[146:147], v[112:113], v[116:117] op_sel:[1,1]
v_pk_mov_b32 v[154:155], v[114:115], v[118:119] op_sel:[0,0]
v_pk_mov_b32 v[162:163], v[114:115], v[118:119] op_sel:[1,1]
L_Bj:
v_subrev_u32 v3, s59, v3
s_waitcnt vmcnt(3)
s_mov_b32 s51, 1048576
global_load_dwordx4 v[48:51], v26, s[26:27] sc1 nt
s_waitcnt vmcnt(3)
v_pk_mov_b32 v[140:141], v[120:121], v[124:125] op_sel:[0,0]
v_pk_mov_b32 v[148:149], v[120:121], v[124:125] op_sel:[1,1]
v_pk_mov_b32 v[156:157], v[122:123], v[126:127] op_sel:[0,0]
v_pk_mov_b32 v[164:165], v[122:123], v[126:127] op_sel:[1,1]
s_waitcnt vmcnt(1)
v_pk_mov_b32 v[142:143], v[128:129], v[132:133] op_sel:[0,0]
v_pk_mov_b32 v[150:151], v[128:129], v[132:133] op_sel:[1,1]
v_pk_mov_b32 v[158:159], v[130:131], v[134:135] op_sel:[0,0]
v_pk_mov_b32 v[166:167], v[130:131], v[134:135] op_sel:[1,1]
L_pollm30:
s_waitcnt vmcnt(0)
v_xor_b32 v48, s54, v48
v_xor_b32 v49, s55, v49
v_xor_b32 v50, s56, v50
v_xor_b32 v51, s57, v51
v_or3_b32 v56, v48, v49, v50
v_or_b32 v56, v56, v51
v_cmp_ne_u32_sdwa vcc, v56, 0 src0_sel:BYTE_0 src1_sel:DWORD
s_cbranch_vccnz L_poll28
L_pollx29:
v_perm_b32 v40, v49, v48, s52
v_perm_b32 v41, v51, v50, s52
s_nop 0
v_mov_b32_dpp v4, v40 quad_perm:[0,0,2,2] row_mask:0xf bank_mask:0xf
v_mov_b32_dpp v5, v41 quad_perm:[0,0,2,2] row_mask:0xf bank_mask:0xf
v_mov_b32_dpp v6, v40 quad_perm:[1,1,3,3] row_mask:0xf bank_mask:0xf
v_mov_b32_dpp v7, v41 quad_perm:[1,1,3,3] row_mask:0xf bank_mask:0xf
s_nop 1
v_smfmac_f32_16x16x64_bf16 v[8:11], v[4:7], v[136:143], v24
v_smfmac_f32_16x16x64_bf16 v[12:15], v[4:7], v[144:151], v24
v_smfmac_f32_16x16x64_bf16 v[16:19], v[4:7], v[152:159], v24
v_smfmac_f32_16x16x64_bf16 v[20:23], v[4:7], v[160:167], v24
s_nop 4
v_add_f32_dpp v40, v10, v8 row_ror:8 row_mask:0xf bank_mask:0x3
v_add_f32_dpp v41, v11, v9 row_ror:8 row_mask:0xf bank_mask:0x3
v_add_f32_dpp v42, v14, v12 row_ror:8 row_mask:0xf bank_mask:0x3
v_add_f32_dpp v43, v15, v13 row_ror:8 row_mask:0xf bank_mask:0x3
v_add_f32_dpp v40, v16, v18 row_ror:8 row_mask:0xf bank_mask:0xc
v_add_f32_dpp v41, v17, v19 row_ror:8 row_mask:0xf bank_mask:0xc
v_add_f32_dpp v42, v20, v22 row_ror:8 row_mask:0xf bank_mask:0xc
v_add_f32_dpp v43, v21, v23 row_ror:8 row_mask:0xf bank_mask:0xc
ds_write_b128 v3, v[40:43] offset:23552
s_cmp_ge_u32 s3, 4
s_waitcnt lgkmcnt(0)
s_barrier
s_cbranch_scc1 L_fin
ds_read2st64_b32 v[8:9], v28 offset0:0 offset1:4
ds_read2st64_b32 v[10:11], v28 offset0:8 offset1:12
ds_read2st64_b32 v[12:13], v28 offset0:16 offset1:20
ds_read2st64_b32 v[14:15], v28 offset0:24 offset1:28
ds_read_b32 v16, v28 offset:8192
s_waitcnt lgkmcnt(3)
v_pk_add_f32 v[8:9], v[8:9], v[10:11]
s_waitcnt lgkmcnt(1)
v_pk_add_f32 v[12:13], v[12:13], v[14:15]
v_pk_add_f32 v[8:9], v[8:9], v[12:13]
s_waitcnt lgkmcnt(0)
v_add_f32 v8, v8, v16
v_add_f32 v8, v8, v9
v_and_or_b32 v8, v8, s63, v29
global_store_dword v27, v8, s[26:27] sc1
s_endpgm
L_far9:
global_store_dwordx4 v5, v[24:27], s[26:27] sc1
s_branch L_pub10
L_far11:
global_store_dwordx2 v4, v[32:33], s[26:27] sc1
s_branch L_pub12
L_aw:
s_waitcnt vmcnt(2)
s_branch L_awx
L_far16:
global_store_dwordx4 v2, v[40:43], s[26:27] sc1
s_branch L_pub17
L_c2:
s_mov_b64 s[36:37], s[18:19]
s_mov_b32 s38, 5308416
s_mov_b32 s39, 0x20000
v_lshrrev_b32 v1, 3, v0
v_mul_u32_u24 v1, 9216, v1
v_and_b32 v3, 7, v0
v_lshl_add_u32 v1, v3, 4, v1
s_lshl2_add_u32 s34, s30, s3
s_sub_u32 s34, s34, 100
s_mul_i32 s34, s34, 1728
s_and_b32 s35, s2, 7
s_mul_i32 s35, s35, 9
s_add_u32 s34, s34, s35
s_add_u32 s34, s34, 8
s_lshl_b32 s34, s34, 7
buffer_load_dwordx4 v[48:51], v1, s[36:39], s34 offen
s_add_u32 s34, s34, 73728
buffer_load_dwordx4 v[52:55], v1, s[36:39], s34 offen
s_add_u32 s34, s34, 73728
buffer_load_dwordx4 v[56:59], v1, s[36:39], s34 offen
s_branch L_c2x
L_far26:
global_store_dwordx4 v2, v[12:15], s[26:27] sc1
s_branch L_pub27
L_Bs:
buffer_load_dwordx4 v[40:43], v1, s[36:39], s48 offen nt
s_add_u32 s48, s48, s61
s_barrier
buffer_load_dwordx4 v[44:47], v1, s[36:39], s48 offen nt
s_add_u32 s48, s48, s61
buffer_load_dwordx4 v[48:51], v1, s[36:39], s48 offen nt
s_add_u32 s48, s48, s61
s_waitcnt vmcnt(2)
buffer_load_dwordx4 v[52:55], v1, s[36:39], s48 offen nt
s_add_u32 s48, s48, s61
s_load_dword s28, s[26:27], 0
s_mov_b64 s[40:41], s[18:19]
s_mov_b32 s42, 5308416
s_mov_b32 s43, 0x20000
s_mov_b64 s[44:45], s[20:21]
s_mov_b32 s46, 5308416
s_mov_b32 s47, 0x20000
s_sub_u32 s60, s30, 16
s_sub_u32 s62, s32, s60
s_add_u32 s62, s62, s3
s_mul_i32 s50, s62, 576
s_add_u32 s50, s50, s60
s_lshl_b32 s50, s50, 7
s_lshl_b32 s33, s3, 7
s_waitcnt vmcnt(2)
buffer_load_dwordx4 v[56:59], v1, s[36:39], s48 offen nt
s_add_u32 s48, s48, s61
v_and_b32 v2, 8, v0
v_lshrrev_b32 v3, 4, v0
v_or_b32 v2, v2, v3
v_mul_u32_u24 v2, 4608, v2
v_and_b32 v3, 7, v0
v_lshl_add_u32 v2, v3, 4, v2
v_bfe_u32 v3, v0, 2, 2
v_lshrrev_b32 v4, 5, v0
v_lshl_add_u32 v3, v3, 1, v4
v_mul_u32_u24 v3, 576, v3
v_bfe_u32 v4, v0, 4, 1
v_and_or_b32 v4, v0, 2, v4
v_lshl_add_u32 v3, v4, 2, v3
s_lshl_b32 s33, s3, 4
s_mov_b32 s52, 0x07060302
s_mov_b32 s53, 0x05040100
v_add_u32 v3, s33, v3
v_pk_mov_b32 v[136:137], v[40:41], v[44:45] op_sel:[0,0]
v_pk_mov_b32 v[144:145], v[40:41], v[44:45] op_sel:[1,1]
v_pk_mov_b32 v[152:153], v[42:43], v[46:47] op_sel:[0,0]
v_pk_mov_b32 v[160:161], v[42:43], v[46:47] op_sel:[1,1]
s_waitcnt vmcnt(2)
buffer_load_dwordx4 v[60:63], v1, s[36:39], s48 offen nt
s_add_u32 s48, s48, s61
v_and_b32 v24, 1, v0
v_mul_u32_u24 v24, 0x5555, v24
v_or_b32 v24, 0x8888, v24
v_mov_b64 v[8:9], 0
v_mov_b64 v[10:11], 0
v_mov_b64 v[12:13], 0
v_mov_b64 v[14:15], 0
v_mov_b64 v[16:17], 0
v_mov_b64 v[18:19], 0
v_mov_b64 v[20:21], 0
v_mov_b64 v[22:23], 0
s_waitcnt vmcnt(2)
buffer_load_dwordx4 v[64:67], v1, s[36:39], s48 offen nt
s_add_u32 s48, s48, s61
v_pk_mov_b32 v[138:139], v[48:49], v[52:53] op_sel:[0,0]
v_pk_mov_b32 v[146:147], v[48:49], v[52:53] op_sel:[1,1]
v_pk_mov_b32 v[154:155], v[50:51], v[54:55] op_sel:[0,0]
v_pk_mov_b32 v[162:163], v[50:51], v[54:55] op_sel:[1,1]
s_waitcnt vmcnt(2)
buffer_load_dwordx4 v[68:71], v1, s[36:39], s48 offen nt
s_waitcnt lgkmcnt(0)
s_and_b32 s29, s28, 0x7f7f7f7f
s_add_u32 s29, s29, 0x07050301
s_and_b32 s28, s28, 0x80808080
s_xor_b32 s29, s29, s28
s_and_b32 s54, s29, 0xff
s_bfe_u32 s55, s29, 0x80008
s_bfe_u32 s56, s29, 0x80010
s_lshr_b32 s57, s29, 24
s_waitcnt vmcnt(2)
v_pk_mov_b32 v[140:141], v[56:57], v[60:61] op_sel:[0,0]
v_pk_mov_b32 v[148:149], v[56:57], v[60:61] op_sel:[1,1]
v_pk_mov_b32 v[156:157], v[58:59], v[62:63] op_sel:[0,0]
v_pk_mov_b32 v[164:165], v[58:59], v[62:63] op_sel:[1,1]
s_waitcnt vmcnt(1)
s_barrier
ds_read2_b32 v[30:31], v3 offset1:36
ds_read2_b32 v[32:33], v3 offset0:72 offset1:108
buffer_load_dwordx4 v[72:75], v1, s[40:43], s49 offen nt
s_add_u32 s49, s49, s61
buffer_load_dwordx4 v[76:79], v1, s[40:43], s49 offen nt
s_add_u32 s49, s49, s61
buffer_load_dwordx4 v[80:83], v1, s[40:43], s49 offen nt
s_add_u32 s49, s49, s61
buffer_load_dwordx4 v[84:87], v1, s[40:43], s49 offen nt
s_add_u32 s49, s49, s61
buffer_load_dwordx4 v[88:91], v1, s[40:43], s49 offen nt
s_add_u32 s49, s49, s61
buffer_load_dwordx4 v[92:95], v1, s[40:43], s49 offen nt
s_add_u32 s49, s49, s61
buffer_load_dwordx4 v[96:99], v1, s[40:43], s49 offen nt
s_add_u32 s49, s49, s61
s_waitcnt vmcnt(7)
buffer_load_dwordx4 v[100:103], v1, s[40:43], s49 offen nt
v_pk_mov_b32 v[142:143], v[64:65], v[68:69] op_sel:[0,0]
v_pk_mov_b32 v[150:151], v[64:65], v[68:69] op_sel:[1,1]
v_pk_mov_b32 v[158:159], v[66:67], v[70:71] op_sel:[0,0]
v_pk_mov_b32 v[166:167], v[66:67], v[70:71] op_sel:[1,1]
s_waitcnt lgkmcnt(0)
v_perm_b32 v4, v31, v30, s53
v_perm_b32 v5, v33, v32, s53
v_perm_b32 v6, v31, v30, s52
v_perm_b32 v7, v33, v32, s52
s_nop 1
v_smfmac_f32_16x16x64_bf16 v[8:11], v[4:7], v[136:143], v24
v_smfmac_f32_16x16x64_bf16 v[12:15], v[4:7], v[144:151], v24
v_smfmac_f32_16x16x64_bf16 v[16:19], v[4:7], v[152:159], v24
v_smfmac_f32_16x16x64_bf16 v[20:23], v[4:7], v[160:167], v24
v_lshrrev_b32 v3, 4, v0
v_mul_u32_u24 v3, 256, v3
v_and_b32 v44, 7, v0
v_lshl_add_u32 v3, v44, 5, v3
v_and_b32 v44, 8, v0
v_lshl_add_u32 v3, v44, 1, v3
s_lshl_b32 s34, s3, 11
v_add_u32 v3, s34, v3
v_mov_b32 v34, 1
v_mov_b32 v35, 23040
v_add_f32_dpp v40, v10, v8 row_ror:8 row_mask:0xf bank_mask:0x3
v_add_f32_dpp v41, v11, v9 row_ror:8 row_mask:0xf bank_mask:0x3
v_add_f32_dpp v42, v14, v12 row_ror:8 row_mask:0xf bank_mask:0x3
v_add_f32_dpp v43, v15, v13 row_ror:8 row_mask:0xf bank_mask:0x3
v_add_f32_dpp v40, v16, v18 row_ror:8 row_mask:0xf bank_mask:0xc
v_add_f32_dpp v41, v17, v19 row_ror:8 row_mask:0xf bank_mask:0xc
v_add_f32_dpp v42, v20, v22 row_ror:8 row_mask:0xf bank_mask:0xc
v_add_f32_dpp v43, v21, v23 row_ror:8 row_mask:0xf bank_mask:0xc
ds_write_b128 v3, v[40:43] offset:4608
s_mov_b64 exec, 1
ds_add_u32 v35, v34 offset:4
s_mov_b64 exec, -1
v_mov_b64 v[8:9], 0
v_mov_b64 v[10:11], 0
v_mov_b64 v[12:13], 0
v_mov_b64 v[14:15], 0
v_mov_b64 v[16:17], 0
v_mov_b64 v[18:19], 0
v_mov_b64 v[20:21], 0
v_mov_b64 v[22:23], 0
s_waitcnt vmcnt(6)
v_pk_mov_b32 v[136:137], v[72:73], v[76:77] op_sel:[0,0]
v_pk_mov_b32 v[144:145], v[72:73], v[76:77] op_sel:[1,1]
v_pk_mov_b32 v[152:153], v[74:75], v[78:79] op_sel:[0,0]
v_pk_mov_b32 v[160:161], v[74:75], v[78:79] op_sel:[1,1]
s_waitcnt vmcnt(4)
v_pk_mov_b32 v[138:139], v[80:81], v[84:85] op_sel:[0,0]
v_pk_mov_b32 v[146:147], v[80:81], v[84:85] op_sel:[1,1]
v_pk_mov_b32 v[154:155], v[82:83], v[86:87] op_sel:[0,0]
v_pk_mov_b32 v[162:163], v[82:83], v[86:87] op_sel:[1,1]
s_waitcnt vmcnt(2)
v_pk_mov_b32 v[140:141], v[88:89], v[92:93] op_sel:[0,0]
v_pk_mov_b32 v[148:149], v[88:89], v[92:93] op_sel:[1,1]
v_pk_mov_b32 v[156:157], v[90:91], v[94:95] op_sel:[0,0]
v_pk_mov_b32 v[164:165], v[90:91], v[94:95] op_sel:[1,1]
s_waitcnt vmcnt(0)
s_barrier
buffer_load_dwordx4 v[104:107], v2, s[44:47], s50 offen offset:0 nt
buffer_load_dwordx4 v[108:111], v2, s[44:47], s50 offen offset:1152 nt
buffer_load_dwordx4 v[112:115], v2, s[44:47], s50 offen offset:2304 nt
v_pk_mov_b32 v[142:143], v[96:97], v[100:101] op_sel:[0,0]
v_pk_mov_b32 v[150:151], v[96:97], v[100:101] op_sel:[1,1]
v_pk_mov_b32 v[158:159], v[98:99], v[102:103] op_sel:[0,0]
v_pk_mov_b32 v[166:167], v[98:99], v[102:103] op_sel:[1,1]
v_smfmac_f32_16x16x64_bf16 v[8:11], v[4:7], v[136:143], v24
v_smfmac_f32_16x16x64_bf16 v[12:15], v[4:7], v[144:151], v24
v_smfmac_f32_16x16x64_bf16 v[16:19], v[4:7], v[152:159], v24
v_smfmac_f32_16x16x64_bf16 v[20:23], v[4:7], v[160:167], v24
s_nop 4
v_add_f32_dpp v44, v10, v8 row_ror:8 row_mask:0xf bank_mask:0x3
v_add_f32_dpp v45, v11, v9 row_ror:8 row_mask:0xf bank_mask:0x3
v_add_f32_dpp v46, v14, v12 row_ror:8 row_mask:0xf bank_mask:0x3
v_add_f32_dpp v47, v15, v13 row_ror:8 row_mask:0xf bank_mask:0x3
v_add_f32_dpp v44, v16, v18 row_ror:8 row_mask:0xf bank_mask:0xc
v_add_f32_dpp v45, v17, v19 row_ror:8 row_mask:0xf bank_mask:0xc
v_add_f32_dpp v46, v20, v22 row_ror:8 row_mask:0xf bank_mask:0xc
v_add_f32_dpp v47, v21, v23 row_ror:8 row_mask:0xf bank_mask:0xc
ds_write_b128 v3, v[44:47] offset:5632
s_mov_b64 exec, 1
ds_add_u32 v35, v34
s_mov_b64 exec, -1
v_mov_b64 v[8:9], 0
v_mov_b64 v[10:11], 0
v_mov_b64 v[12:13], 0
v_mov_b64 v[14:15], 0
v_mov_b64 v[16:17], 0
v_mov_b64 v[18:19], 0
v_mov_b64 v[20:21], 0
v_mov_b64 v[22:23], 0
s_waitcnt vmcnt(2)
buffer_load_dwordx4 v[116:119], v2, s[44:47], s50 offen offset:3456 nt
s_add_u32 s50, s50, 18432
s_waitcnt vmcnt(2)
buffer_load_dwordx4 v[120:123], v2, s[44:47], s50 offen offset:0 nt
v_pk_mov_b32 v[136:137], v[104:105], v[108:109] op_sel:[0,0]
v_pk_mov_b32 v[144:145], v[104:105], v[108:109] op_sel:[1,1]
v_pk_mov_b32 v[152:153], v[106:107], v[110:111] op_sel:[0,0]
v_pk_mov_b32 v[160:161], v[106:107], v[110:111] op_sel:[1,1]
s_lshl_b32 s33, s62, 10
s_add_u32 s33, s33, 425984
v_lshl_add_u32 v26, v0, 4, s33
s_mov_b32 s52, 0x07060302
s_and_b32 s33, s2, 7
s_mul_i32 s33, s33, 48
s_mul_i32 s34, s3, 9
s_add_u32 s33, s33, s34
s_add_u32 s33, s33, s60
s_lshl_b32 s33, s33, 8
s_add_u32 s33, s33, 524288
v_lshl_add_u32 v27, v0, 2, s33
s_lshl_b32 s34, s3, 8
s_add_u32 s34, s34, 23552
v_lshl_add_u32 v28, v0, 2, s34
v_and_b32 v29, 3, v0
v_lshlrev_b32 v29, 3, v29
v_bfe_u32 v29, s29, v29, 8
s_mov_b32 s63, 0xffffff00
s_lshl_b32 s59, s3, 10
s_waitcnt vmcnt(2)
buffer_load_dwordx4 v[124:127], v2, s[44:47], s50 offen offset:1152 nt
s_waitcnt vmcnt(2)
buffer_load_dwordx4 v[128:131], v2, s[44:47], s50 offen offset:2304 nt
v_pk_mov_b32 v[138:139], v[112:113], v[116:117] op_sel:[0,0]
v_pk_mov_b32 v[146:147], v[112:113], v[116:117] op_sel:[1,1]
v_pk_mov_b32 v[154:155], v[114:115], v[118:119] op_sel:[0,0]
v_pk_mov_b32 v[162:163], v[114:115], v[118:119] op_sel:[1,1]
s_waitcnt vmcnt(2)
buffer_load_dwordx4 v[132:135], v2, s[44:47], s50 offen offset:3456 nt
s_branch L_Bj
L_poll28:
s_sub_u32 s51, s51, 1
s_cbranch_scc1 L_pollx29
global_load_dwordx4 v[48:51], v26, s[26:27] sc1 nt
s_branch L_pollm30
L_exit:
L_last:
s_endpgm
.section .rodata,"a"
.p2align 6
.amdhsa_kernel recurrent_scan__sliding_block_cached__glu_gated_geglu__decode_kernel
  .amdhsa_next_free_vgpr 168
  .amdhsa_next_free_sgpr 64
  .amdhsa_accum_offset 168
  .amdhsa_group_segment_fixed_size 0
  .amdhsa_kernarg_size 96
  .amdhsa_user_sgpr_count 2
  .amdhsa_user_sgpr_kernarg_segment_ptr 1
  .amdhsa_system_sgpr_workgroup_id_x 1
.end_amdhsa_kernel
```
